```python
import torch

def _softmax(x, axis=-1):
    return torch.softmax(x, dim=axis)
def _gelu(x):
    return torch.nn.functional.gelu(x, approximate="tanh")
def _silu(x):
    return torch.nn.functional.silu(x)
def _sigmoid(x):
    return torch.sigmoid(x)
def _layernorm(x, axis=-1, eps=1e-5):
    m = x.mean(dim=axis, keepdim=True)
    v = x.var(dim=axis, keepdim=True, unbiased=False)
    return (x - m) / torch.sqrt(v + eps)
def _scatter_add(tgt, idx, src, axis=0):
    return tgt.clone().index_add_(axis, idx, src)
def _segment_sum(src, seg, n):
    out = torch.zeros((n,) + src.shape[1:], dtype=src.dtype)
    return out.index_add_(0, seg, src)
def _pad(x, pw):
    flat = tuple(v for pair in reversed(pw) for v in pair)
    return torch.nn.functional.pad(x, flat)

kernel_name = 'standalone__deep_cross_wide_deep__recsys'

def setup_inputs():

    _w = (lambda a: (lambda t: t.to(torch.bfloat16) if t.is_floating_point() else t)(torch.as_tensor(a)))
    B, F, D = 16384, 100, 32
    V, Nd = min(100000, 100000), 13
    Din = F * D
    H = 4 * D
    return {
        "idx": _w((lambda lo, hi, *s: torch.randint(lo, hi, s))(0, V, B, F).to(torch.int64)),
        "table": _w((lambda *s: torch.randn(*s, dtype=torch.bfloat16) * 1.6)(V, D) * 0.05),
        "x_wide": _w((lambda *s: torch.randn(*s, dtype=torch.bfloat16) * 0.8)(B, Nd)),
        "w_wide": _w((lambda *s: torch.randn(*s, dtype=torch.bfloat16) * 0.8)(Nd) * 0.05),
        "b_wide": _w((lambda *s: torch.randn(*s, dtype=torch.bfloat16) * 0.8)(1) * 0.01),
        "W1": _w((lambda *s: torch.randn(*s, dtype=torch.bfloat16) * 1.6)(Din, H) * (2.0 / Din) ** 0.5),
        "b1": _w((lambda *s: torch.randn(*s, dtype=torch.bfloat16) * 1.6)(H) * 0.01),
        "W2": _w((lambda *s: torch.randn(*s, dtype=torch.bfloat16) * 1.6)(H) * (1.0 / H) ** 0.5),
        "b2": _w((lambda *s: torch.randn(*s, dtype=torch.bfloat16) * 1.6)(1) * 0.01),
    }

def reference(idx, table, x_wide, w_wide, b_wide, W1, b1, W2, b2):
    emb = table[idx]
    deep_in = emb.reshape(emb.shape[0], -1)
    h = deep_in @ W1 + b1
    h = h * (lambda x, dt: x.to(dt))(h > 0, h.dtype)
    deep_logit = h @ W2 + b2
    wide_logit = x_wide @ w_wide + b_wide
    return _sigmoid(wide_logit + deep_logit)
```

```asm
; @launch grid=(256,1,1) block=(256,1,1) lds=161792
.amdgcn_target "amdgcn-amd-amdhsa--gfx950"
.text
.globl standalone__deep_cross_wide_deep__recsys_kernel
.p2align 8
.type standalone__deep_cross_wide_deep__recsys_kernel,@function
standalone__deep_cross_wide_deep__recsys_kernel:
    s_cmp_ge_u32 s2, 256
    s_cbranch_scc1 L_end
    s_load_dwordx16 s[36:51], s[0:1], 0
    s_load_dwordx4 s[52:55], s[0:1], 64
    s_load_dwordx2 s[58:59], s[0:1], 88
    v_and_b32 v1, 63, v0
    v_lshrrev_b32 v12, 6, v0
    s_nop 0
    v_readfirstlane_b32 s64, v12
    v_add_u32 v16, 0, v1
    v_mul_u32_u24 v17, 5042, v16
    v_lshrrev_b32 v17, 16, v17
    v_mul_u32_u24 v18, 13, v17
    v_sub_u32 v18, v16, v18
    v_mul_u32_u24 v17, 400, v17
    v_lshl_add_u32 v36, v18, 4, v17
    v_add_u32 v16, 64, v1
    v_mul_u32_u24 v17, 5042, v16
    v_lshrrev_b32 v17, 16, v17
    v_mul_u32_u24 v18, 13, v17
    v_sub_u32 v18, v16, v18
    v_mul_u32_u24 v17, 400, v17
    v_lshl_add_u32 v37, v18, 4, v17
    v_subrev_u32 v37, 1024, v37
    v_add_u32 v16, 128, v1
    v_mul_u32_u24 v17, 5042, v16
    v_lshrrev_b32 v17, 16, v17
    v_mul_u32_u24 v18, 13, v17
    v_sub_u32 v18, v16, v18
    v_mul_u32_u24 v17, 400, v17
    v_lshl_add_u32 v38, v18, 4, v17
    v_subrev_u32 v38, 2048, v38
    v_add_u32 v16, 192, v1
    v_mul_u32_u24 v17, 5042, v16
    v_lshrrev_b32 v17, 16, v17
    v_mul_u32_u24 v18, 13, v17
    v_sub_u32 v18, v16, v18
    v_mul_u32_u24 v17, 400, v17
    v_lshl_add_u32 v39, v18, 4, v17
    v_subrev_u32 v39, 3072, v39
    v_bfe_u32 v17, v1, 4, 2
    v_and_b32 v16, 15, v1
    v_lshlrev_b32 v18, 2, v17
    v_xor_b32 v16, v16, v18
    v_lshlrev_b32 v16, 4, v16
    v_lshl_add_u32 v3, v17, 8, v16
    s_lshr_b32 s65, s2, 3
    s_and_b32 s65, s65, 1
    s_lshr_b32 s71, s2, 4
    s_lshl_b32 s72, s71, 3
    s_and_b32 s75, s2, 7
    s_add_u32 s72, s72, s75
    s_lshl_b32 s72, s72, 7
    s_lshl_b32 s75, s65, 6
    s_add_u32 s75, s75, s72
    s_mul_i32 s71, s71, 25
    s_lshr_b32 s71, s71, 4
    s_lshl_b32 s66, s71, 3
    s_mov_b32 s67, s66
    s_lshl_b32 s68, s71, 14
    s_lshl_b32 s69, s64, 11
    s_lshl_b32 s70, s64, 10
    s_mul_i32 s73, s65, 409600
    s_add_u32 s73, s73, s69
    s_xor_b32 s71, s75, 64
    s_lshl_b32 s72, s64, 4
    s_add_u32 s71, s71, s72
    s_mul_i32 s71, s71, 400
    s_mul_i32 s74, s65, 192
    s_add_u32 s71, s71, s74
    s_mul_i32 s72, s64, 3328
    s_waitcnt lgkmcnt(0)
    s_mov_b32 s16, s46
    s_and_b32 s17, s47, 0xffff
    s_mov_b32 s18, 819200
    s_mov_b32 s19, 0x20000
    s_mov_b32 s8, s36
    s_and_b32 s9, s37, 0xffff
    s_mov_b32 s10, 6553600
    s_mov_b32 s11, 0x20000
    s_add_u32 m0, s72, 131072
    s_nop 0
    buffer_load_dwordx4 v36, s[8:11], s71 offen offset:0 lds
    buffer_load_dwordx4 v37, s[8:11], s71 offen offset:1024 lds
    buffer_load_dwordx4 v38, s[8:11], s71 offen offset:2048 lds
    s_mov_b64 exec, 0xffff
    buffer_load_dwordx4 v39, s[8:11], s71 offen offset:3072 lds
    s_mov_b64 exec, -1
    s_lshl_b32 s74, s65, 1
    s_sub_u32 s74, s74, 1
    s_mul_i32 s74, s74, 25600
    s_add_u32 s71, s71, s74
    s_add_u32 m0, s72, 144384
    s_nop 0
    buffer_load_dwordx4 v36, s[8:11], s71 offen offset:0 lds
    buffer_load_dwordx4 v37, s[8:11], s71 offen offset:1024 lds
    buffer_load_dwordx4 v38, s[8:11], s71 offen offset:2048 lds
    s_mov_b64 exec, 0xffff
    buffer_load_dwordx4 v39, s[8:11], s71 offen offset:3072 lds
    s_mov_b64 exec, -1
    s_mov_b32 s12, s38
    s_and_b32 s13, s39, 0xffff
    s_mov_b32 s14, 6400000
    s_mov_b32 s15, 0x20000
    s_load_dword s4, s[38:39], 0
    s_mov_b32 s5, 2097152
    s_load_dword s4, s[38:39], s5
    s_mov_b32 s5, 4194304
    s_load_dword s4, s[38:39], s5
    s_mov_b32 s5, 6291456
    s_load_dword s4, s[38:39], s5
    s_add_u32 m0, s69, 0
    s_add_u32 s74, s68, s73
    buffer_load_dwordx4 v3, s[16:19], s74 offen offset:0 lds
    buffer_load_dwordx4 v3, s[16:19], s74 offen offset:1024 lds
    s_add_u32 s68, s68, 8192
    s_cmp_ge_u32 s68, 409600
    s_cselect_b32 s68, 0, s68
    s_add_u32 m0, s69, 8192
    s_add_u32 s74, s68, s73
    buffer_load_dwordx4 v3, s[16:19], s74 offen offset:0 lds
    buffer_load_dwordx4 v3, s[16:19], s74 offen offset:1024 lds
    s_add_u32 s68, s68, 8192
    s_cmp_ge_u32 s68, 409600
    s_cselect_b32 s68, 0, s68
    s_add_u32 m0, s69, 16384
    s_add_u32 s74, s68, s73
    buffer_load_dwordx4 v3, s[16:19], s74 offen offset:0 lds
    buffer_load_dwordx4 v3, s[16:19], s74 offen offset:1024 lds
    s_add_u32 s68, s68, 8192
    s_cmp_ge_u32 s68, 409600
    s_cselect_b32 s68, 0, s68
    s_add_u32 m0, s69, 24576
    s_add_u32 s74, s68, s73
    buffer_load_dwordx4 v3, s[16:19], s74 offen offset:0 lds
    buffer_load_dwordx4 v3, s[16:19], s74 offen offset:1024 lds
    s_add_u32 s68, s68, 8192
    s_cmp_ge_u32 s68, 409600
    s_cselect_b32 s68, 0, s68
    s_add_u32 m0, s69, 32768
    s_add_u32 s74, s68, s73
    buffer_load_dwordx4 v3, s[16:19], s74 offen offset:0 lds
    buffer_load_dwordx4 v3, s[16:19], s74 offen offset:1024 lds
    s_add_u32 s68, s68, 8192
    s_cmp_ge_u32 s68, 409600
    s_cselect_b32 s68, 0, s68
    s_add_u32 m0, s69, 40960
    s_add_u32 s74, s68, s73
    buffer_load_dwordx4 v3, s[16:19], s74 offen offset:0 lds
    buffer_load_dwordx4 v3, s[16:19], s74 offen offset:1024 lds
    s_add_u32 s68, s68, 8192
    s_cmp_ge_u32 s68, 409600
    s_cselect_b32 s68, 0, s68
    v_and_b32 v16, 3, v1
    v_bfe_u32 v17, v1, 4, 2
    v_xor_b32 v16, v16, v17
    v_lshlrev_b32 v2, 4, v16
    v_lshrrev_b32 v16, 2, v1
    v_mul_u32_u24 v4, 208, v16
    s_lshl_b32 s71, s65, 3
    s_add_u32 s71, s71, s72
    s_add_u32 s71, s71, 131072
    v_add_u32 v4, s71, v4
    v_and_b32 v16, 31, v1
    v_lshlrev_b32 v16, 6, v16
    v_add_u32 v16, 81920, v16
    v_lshrrev_b32 v17, 5, v1
    v_bfe_u32 v18, v1, 2, 2
    v_xor_b32 v19, v17, v18
    v_lshl_add_u32 v5, v19, 4, v16
    v_xor_b32 v19, 2, v19
    v_lshl_add_u32 v6, v19, 4, v16
    v_lshl_add_u32 v19, v17, 3, v18
    v_lshlrev_b32 v19, 8, v19
    v_bfe_u32 v20, v1, 4, 1
    v_lshlrev_b32 v20, 1, v20
    v_bfe_u32 v21, v1, 1, 1
    v_add_u32 v20, v20, v21
    s_lshl_b32 s71, s64, 2
    v_add_u32 v20, s71, v20
    v_lshlrev_b32 v18, 2, v18
    v_xor_b32 v20, v20, v18
    v_and_b32 v21, 1, v1
    v_lshlrev_b32 v21, 3, v21
    v_add_u32 v19, v19, v21
    v_lshl_add_u32 v7, v20, 4, v19
    v_add_u32 v13, 65536, v7
    s_lshl_b32 s77, s2, 14
    s_xor_b32 s71, s2, 8
    s_lshl_b32 s76, s71, 14
    s_lshl_b32 s71, s64, 12
    s_add_u32 s77, s77, s71
    s_add_u32 s76, s76, s71
    s_mov_b32 s24, s54
    s_and_b32 s25, s55, 0xffff
    s_mov_b32 s26, 32768
    s_mov_b32 s27, 0x20000
    s_mov_b32 s32, s58
    s_and_b32 s33, s59, 0xffff
    s_mov_b32 s34, 4259840
    s_mov_b32 s35, 0x20000
    s_waitcnt vmcnt(8)
    s_barrier
    ds_read_b64_tr_b16 v[112:113], v7 offset:0
    ds_read_b64_tr_b16 v[114:115], v7 offset:1024
    s_add_u32 m0, s69, 49152
    s_add_u32 s74, s68, s73
    buffer_load_dwordx4 v3, s[16:19], s74 offen offset:0 lds
    ds_read_b64_tr_b16 v[116:117], v7 offset:4096
    ds_read_b64_tr_b16 v[118:119], v7 offset:5120
    buffer_load_dwordx4 v3, s[16:19], s74 offen offset:1024 lds
    s_add_u32 s68, s68, 8192
    s_cmp_ge_u32 s68, 409600
    s_cselect_b32 s68, 0, s68
    ds_read_b64_tr_b16 v[120:121], v7 offset:8192
    ds_read_b64_tr_b16 v[122:123], v7 offset:9216
    s_add_u32 m0, s69, 57344
    s_add_u32 s74, s68, s73
    buffer_load_dwordx4 v3, s[16:19], s74 offen offset:0 lds
    ds_read_b64_tr_b16 v[124:125], v7 offset:12288
    ds_read_b64_tr_b16 v[126:127], v7 offset:13312
    buffer_load_dwordx4 v3, s[16:19], s74 offen offset:1024 lds
    s_add_u32 s68, s68, 8192
    s_cmp_ge_u32 s68, 409600
    s_cselect_b32 s68, 0, s68
    s_add_u32 m0, s69, 65536
    s_add_u32 s74, s68, s73
    buffer_load_dwordx4 v3, s[16:19], s74 offen offset:0 lds
    buffer_load_dwordx4 v3, s[16:19], s74 offen offset:1024 lds
    s_add_u32 s68, s68, 8192
    s_cmp_ge_u32 s68, 409600
    s_cselect_b32 s68, 0, s68
    s_add_u32 m0, s69, 73728
    s_add_u32 s74, s68, s73
    buffer_load_dwordx4 v3, s[16:19], s74 offen offset:0 lds
    buffer_load_dwordx4 v3, s[16:19], s74 offen offset:1024 lds
    s_add_u32 s68, s68, 8192
    s_cmp_ge_u32 s68, 409600
    s_cselect_b32 s68, 0, s68
    s_waitcnt vmcnt(12)
    s_waitcnt lgkmcnt(0)
    s_barrier
    ds_read_b64_tr_b16 v[128:129], v7 offset:16384
    ds_read_b64_tr_b16 v[130:131], v7 offset:17408
    s_add_u32 m0, s69, 81920
    s_add_u32 s74, s68, s73
    buffer_load_dwordx4 v3, s[16:19], s74 offen offset:0 lds
    ds_read_b64_tr_b16 v[132:133], v7 offset:20480
    ds_read_b64_tr_b16 v[134:135], v7 offset:21504
    buffer_load_dwordx4 v3, s[16:19], s74 offen offset:1024 lds
    s_add_u32 s68, s68, 8192
    s_cmp_ge_u32 s68, 409600
    s_cselect_b32 s68, 0, s68
    ds_read_b64_tr_b16 v[136:137], v7 offset:24576
    ds_read_b64_tr_b16 v[138:139], v7 offset:25600
    s_add_u32 m0, s69, 90112
    s_add_u32 s74, s68, s73
    buffer_load_dwordx4 v3, s[16:19], s74 offen offset:0 lds
    ds_read_b64_tr_b16 v[140:141], v7 offset:28672
    ds_read_b64_tr_b16 v[142:143], v7 offset:29696
    buffer_load_dwordx4 v3, s[16:19], s74 offen offset:1024 lds
    s_add_u32 s68, s68, 8192
    s_cmp_ge_u32 s68, 409600
    s_cselect_b32 s68, 0, s68
    s_add_u32 m0, s69, 0
    s_add_u32 s74, s68, s73
    buffer_load_dwordx4 v3, s[16:19], s74 offen offset:0 lds
    buffer_load_dwordx4 v3, s[16:19], s74 offen offset:1024 lds
    s_add_u32 s68, s68, 8192
    s_cmp_ge_u32 s68, 409600
    s_cselect_b32 s68, 0, s68
    s_add_u32 m0, s69, 8192
    s_add_u32 s74, s68, s73
    buffer_load_dwordx4 v3, s[16:19], s74 offen offset:0 lds
    buffer_load_dwordx4 v3, s[16:19], s74 offen offset:1024 lds
    s_add_u32 s68, s68, 8192
    s_cmp_ge_u32 s68, 409600
    s_cselect_b32 s68, 0, s68
    s_waitcnt vmcnt(16)
    s_waitcnt lgkmcnt(0)
    s_barrier
    ds_read_b64_tr_b16 v[144:145], v7 offset:32768
    ds_read_b64_tr_b16 v[146:147], v7 offset:33792
    s_add_u32 m0, s69, 16384
    s_add_u32 s74, s68, s73
    buffer_load_dwordx4 v3, s[16:19], s74 offen offset:0 lds
    ds_read_b64_tr_b16 v[148:149], v7 offset:36864
    ds_read_b64_tr_b16 v[150:151], v7 offset:37888
    buffer_load_dwordx4 v3, s[16:19], s74 offen offset:1024 lds
    s_add_u32 s68, s68, 8192
    s_cmp_ge_u32 s68, 409600
    s_cselect_b32 s68, 0, s68
    ds_read_b64_tr_b16 v[152:153], v7 offset:40960
    ds_read_b64_tr_b16 v[154:155], v7 offset:41984
    s_add_u32 m0, s69, 24576
    s_add_u32 s74, s68, s73
    buffer_load_dwordx4 v3, s[16:19], s74 offen offset:0 lds
    ds_read_b64_tr_b16 v[156:157], v7 offset:45056
    ds_read_b64_tr_b16 v[158:159], v7 offset:46080
    buffer_load_dwordx4 v3, s[16:19], s74 offen offset:1024 lds
    s_add_u32 s68, s68, 8192
    s_cmp_ge_u32 s68, 409600
    s_cselect_b32 s68, 0, s68
    s_waitcnt vmcnt(16)
    s_waitcnt lgkmcnt(0)
    s_barrier
    ds_read_b64_tr_b16 v[160:161], v7 offset:49152
    ds_read_b64_tr_b16 v[162:163], v7 offset:50176
    s_add_u32 m0, s69, 32768
    s_add_u32 s74, s68, s73
    buffer_load_dwordx4 v3, s[16:19], s74 offen offset:0 lds
    ds_read_b64_tr_b16 v[164:165], v7 offset:53248
    ds_read_b64_tr_b16 v[166:167], v7 offset:54272
    buffer_load_dwordx4 v3, s[16:19], s74 offen offset:1024 lds
    s_add_u32 s68, s68, 8192
    s_cmp_ge_u32 s68, 409600
    s_cselect_b32 s68, 0, s68
    ds_read_b64_tr_b16 v[168:169], v7 offset:57344
    ds_read_b64_tr_b16 v[170:171], v7 offset:58368
    s_add_u32 m0, s69, 40960
    s_add_u32 s74, s68, s73
    buffer_load_dwordx4 v3, s[16:19], s74 offen offset:0 lds
    ds_read_b64_tr_b16 v[172:173], v7 offset:61440
    ds_read_b64_tr_b16 v[174:175], v7 offset:62464
    buffer_load_dwordx4 v3, s[16:19], s74 offen offset:1024 lds
    s_add_u32 s68, s68, 8192
    s_cmp_ge_u32 s68, 409600
    s_cselect_b32 s68, 0, s68
    s_waitcnt vmcnt(16)
    s_waitcnt lgkmcnt(0)
    s_barrier
    ds_read_b64_tr_b16 v[176:177], v13 offset:0
    ds_read_b64_tr_b16 v[178:179], v13 offset:1024
    s_add_u32 m0, s69, 49152
    s_add_u32 s74, s68, s73
    buffer_load_dwordx4 v3, s[16:19], s74 offen offset:0 lds
    ds_read_b64_tr_b16 v[180:181], v13 offset:4096
    ds_read_b64_tr_b16 v[182:183], v13 offset:5120
    buffer_load_dwordx4 v3, s[16:19], s74 offen offset:1024 lds
    s_add_u32 s68, s68, 8192
    s_cmp_ge_u32 s68, 409600
    s_cselect_b32 s68, 0, s68
    ds_read_b64_tr_b16 v[184:185], v13 offset:8192
    ds_read_b64_tr_b16 v[186:187], v13 offset:9216
    s_add_u32 m0, s69, 57344
    s_add_u32 s74, s68, s73
    buffer_load_dwordx4 v3, s[16:19], s74 offen offset:0 lds
    ds_read_b64_tr_b16 v[188:189], v13 offset:12288
    ds_read_b64_tr_b16 v[190:191], v13 offset:13312
    buffer_load_dwordx4 v3, s[16:19], s74 offen offset:1024 lds
    s_add_u32 s68, s68, 8192
    s_cmp_ge_u32 s68, 409600
    s_cselect_b32 s68, 0, s68
    s_waitcnt vmcnt(16)
    s_waitcnt lgkmcnt(0)
    s_barrier
    ds_read_b64_tr_b16 v[192:193], v13 offset:16384
    ds_read_b64_tr_b16 v[194:195], v13 offset:17408
    s_add_u32 m0, s69, 65536
    s_add_u32 s74, s68, s73
    buffer_load_dwordx4 v3, s[16:19], s74 offen offset:0 lds
    ds_read_b64_tr_b16 v[196:197], v13 offset:20480
    ds_read_b64_tr_b16 v[198:199], v13 offset:21504
    buffer_load_dwordx4 v3, s[16:19], s74 offen offset:1024 lds
    s_add_u32 s68, s68, 8192
    s_cmp_ge_u32 s68, 409600
    s_cselect_b32 s68, 0, s68
    ds_read_b64_tr_b16 v[200:201], v13 offset:24576
    ds_read_b64_tr_b16 v[202:203], v13 offset:25600
    s_add_u32 m0, s69, 73728
    s_add_u32 s74, s68, s73
    buffer_load_dwordx4 v3, s[16:19], s74 offen offset:0 lds
    ds_read_b64_tr_b16 v[204:205], v13 offset:28672
    ds_read_b64_tr_b16 v[206:207], v13 offset:29696
    buffer_load_dwordx4 v3, s[16:19], s74 offen offset:1024 lds
    s_add_u32 s68, s68, 8192
    s_cmp_ge_u32 s68, 409600
    s_cselect_b32 s68, 0, s68
    s_waitcnt vmcnt(16)
    s_waitcnt lgkmcnt(0)
    s_barrier
    ds_read_b64_tr_b16 v[208:209], v7 offset:0
    ds_read_b64_tr_b16 v[210:211], v7 offset:1024
    s_add_u32 m0, s69, 81920
    s_add_u32 s74, s68, s73
    buffer_load_dwordx4 v3, s[16:19], s74 offen offset:0 lds
    ds_read_b64_tr_b16 v[212:213], v7 offset:4096
    ds_read_b64_tr_b16 v[214:215], v7 offset:5120
    buffer_load_dwordx4 v3, s[16:19], s74 offen offset:1024 lds
    s_add_u32 s68, s68, 8192
    s_cmp_ge_u32 s68, 409600
    s_cselect_b32 s68, 0, s68
    ds_read_b64_tr_b16 v[216:217], v7 offset:8192
    ds_read_b64_tr_b16 v[218:219], v7 offset:9216
    s_add_u32 m0, s69, 90112
    s_add_u32 s74, s68, s73
    buffer_load_dwordx4 v3, s[16:19], s74 offen offset:0 lds
    ds_read_b64_tr_b16 v[220:221], v7 offset:12288
    ds_read_b64_tr_b16 v[222:223], v7 offset:13312
    buffer_load_dwordx4 v3, s[16:19], s74 offen offset:1024 lds
    s_add_u32 s68, s68, 8192
    s_cmp_ge_u32 s68, 409600
    s_cselect_b32 s68, 0, s68
    s_waitcnt vmcnt(16)
    s_waitcnt lgkmcnt(0)
    s_barrier
    ds_read_b64_tr_b16 v[224:225], v7 offset:16384
    ds_read_b64_tr_b16 v[226:227], v7 offset:17408
    s_add_u32 m0, s69, 0
    s_add_u32 s74, s68, s73
    buffer_load_dwordx4 v3, s[16:19], s74 offen offset:0 lds
    ds_read_b64_tr_b16 v[228:229], v7 offset:20480
    ds_read_b64_tr_b16 v[230:231], v7 offset:21504
    buffer_load_dwordx4 v3, s[16:19], s74 offen offset:1024 lds
    s_add_u32 s68, s68, 8192
    s_cmp_ge_u32 s68, 409600
    s_cselect_b32 s68, 0, s68
    ds_read_b64_tr_b16 v[232:233], v7 offset:24576
    ds_read_b64_tr_b16 v[234:235], v7 offset:25600
    s_add_u32 m0, s69, 8192
    s_add_u32 s74, s68, s73
    buffer_load_dwordx4 v3, s[16:19], s74 offen offset:0 lds
    ds_read_b64_tr_b16 v[236:237], v7 offset:28672
    ds_read_b64_tr_b16 v[238:239], v7 offset:29696
    buffer_load_dwordx4 v3, s[16:19], s74 offen offset:1024 lds
    s_add_u32 s68, s68, 8192
    s_cmp_ge_u32 s68, 409600
    s_cselect_b32 s68, 0, s68
    s_waitcnt vmcnt(16)
    s_waitcnt lgkmcnt(0)
    s_barrier
    ds_read_b64_tr_b16 v[240:241], v7 offset:32768
    ds_read_b64_tr_b16 v[242:243], v7 offset:33792
    s_add_u32 m0, s69, 16384
    s_add_u32 s74, s68, s73
    buffer_load_dwordx4 v3, s[16:19], s74 offen offset:0 lds
    ds_read_b64_tr_b16 v[244:245], v7 offset:36864
    ds_read_b64_tr_b16 v[246:247], v7 offset:37888
    buffer_load_dwordx4 v3, s[16:19], s74 offen offset:1024 lds
    s_add_u32 s68, s68, 8192
    s_cmp_ge_u32 s68, 409600
    s_cselect_b32 s68, 0, s68
    ds_read_b64_tr_b16 v[248:249], v7 offset:40960
    ds_read_b64_tr_b16 v[250:251], v7 offset:41984
    s_add_u32 m0, s69, 24576
    s_add_u32 s74, s68, s73
    buffer_load_dwordx4 v3, s[16:19], s74 offen offset:0 lds
    ds_read_b64_tr_b16 v[252:253], v7 offset:45056
    ds_read_b64_tr_b16 v[254:255], v7 offset:46080
    buffer_load_dwordx4 v3, s[16:19], s74 offen offset:1024 lds
    s_add_u32 s68, s68, 8192
    s_cmp_ge_u32 s68, 409600
    s_cselect_b32 s68, 0, s68
    s_waitcnt vmcnt(16)
    s_waitcnt lgkmcnt(0)
    s_barrier
    ds_read_b64_tr_b16 a[0:1], v7 offset:49152
    ds_read_b64_tr_b16 a[2:3], v7 offset:50176
    s_add_u32 m0, s69, 32768
    s_add_u32 s74, s68, s73
    buffer_load_dwordx4 v3, s[16:19], s74 offen offset:0 lds
    ds_read_b64_tr_b16 a[4:5], v7 offset:53248
    ds_read_b64_tr_b16 a[6:7], v7 offset:54272
    buffer_load_dwordx4 v3, s[16:19], s74 offen offset:1024 lds
    s_add_u32 s68, s68, 8192
    s_cmp_ge_u32 s68, 409600
    s_cselect_b32 s68, 0, s68
    ds_read_b64_tr_b16 a[8:9], v7 offset:57344
    ds_read_b64_tr_b16 a[10:11], v7 offset:58368
    s_add_u32 m0, s69, 40960
    s_add_u32 s74, s68, s73
    buffer_load_dwordx4 v3, s[16:19], s74 offen offset:0 lds
    ds_read_b64_tr_b16 a[12:13], v7 offset:61440
    ds_read_b64_tr_b16 a[14:15], v7 offset:62464
    buffer_load_dwordx4 v3, s[16:19], s74 offen offset:1024 lds
    s_add_u32 s68, s68, 8192
    s_cmp_ge_u32 s68, 409600
    s_cselect_b32 s68, 0, s68
    s_waitcnt vmcnt(16)
    s_waitcnt lgkmcnt(0)
    s_barrier
    ds_read_b64_tr_b16 a[16:17], v13 offset:0
    ds_read_b64_tr_b16 a[18:19], v13 offset:1024
    s_add_u32 m0, s69, 49152
    s_add_u32 s74, s68, s73
    buffer_load_dwordx4 v3, s[16:19], s74 offen offset:0 lds
    ds_read_b64_tr_b16 a[20:21], v13 offset:4096
    ds_read_b64_tr_b16 a[22:23], v13 offset:5120
    buffer_load_dwordx4 v3, s[16:19], s74 offen offset:1024 lds
    s_add_u32 s68, s68, 8192
    s_cmp_ge_u32 s68, 409600
    s_cselect_b32 s68, 0, s68
    ds_read_b64_tr_b16 a[24:25], v13 offset:8192
    ds_read_b64_tr_b16 a[26:27], v13 offset:9216
    s_add_u32 m0, s69, 57344
    s_add_u32 s74, s68, s73
    buffer_load_dwordx4 v3, s[16:19], s74 offen offset:0 lds
    ds_read_b64_tr_b16 a[28:29], v13 offset:12288
    ds_read_b64_tr_b16 a[30:31], v13 offset:13312
    buffer_load_dwordx4 v3, s[16:19], s74 offen offset:1024 lds
    s_add_u32 s68, s68, 8192
    s_cmp_ge_u32 s68, 409600
    s_cselect_b32 s68, 0, s68
    s_waitcnt vmcnt(16)
    s_waitcnt lgkmcnt(0)
    s_barrier
    ds_read_b64_tr_b16 a[32:33], v13 offset:16384
    ds_read_b64_tr_b16 a[34:35], v13 offset:17408
    s_add_u32 m0, s69, 65536
    s_add_u32 s74, s68, s73
    buffer_load_dwordx4 v3, s[16:19], s74 offen offset:0 lds
    ds_read_b64_tr_b16 a[36:37], v13 offset:20480
    ds_read_b64_tr_b16 a[38:39], v13 offset:21504
    buffer_load_dwordx4 v3, s[16:19], s74 offen offset:1024 lds
    s_add_u32 s68, s68, 8192
    s_cmp_ge_u32 s68, 409600
    s_cselect_b32 s68, 0, s68
    ds_read_b64_tr_b16 a[40:41], v13 offset:24576
    ds_read_b64_tr_b16 a[42:43], v13 offset:25600
    s_add_u32 m0, s69, 73728
    s_add_u32 s74, s68, s73
    buffer_load_dwordx4 v3, s[16:19], s74 offen offset:0 lds
    ds_read_b64_tr_b16 a[44:45], v13 offset:28672
    ds_read_b64_tr_b16 a[46:47], v13 offset:29696
    buffer_load_dwordx4 v3, s[16:19], s74 offen offset:1024 lds
    s_add_u32 s68, s68, 8192
    s_cmp_ge_u32 s68, 409600
    s_cselect_b32 s68, 0, s68
    s_waitcnt vmcnt(16)
    s_waitcnt lgkmcnt(0)
    s_barrier
    ds_read_b64_tr_b16 a[48:49], v7 offset:0
    ds_read_b64_tr_b16 a[50:51], v7 offset:1024
    s_add_u32 m0, s69, 81920
    s_add_u32 s74, s68, s73
    buffer_load_dwordx4 v3, s[16:19], s74 offen offset:0 lds
    ds_read_b64_tr_b16 a[52:53], v7 offset:4096
    ds_read_b64_tr_b16 a[54:55], v7 offset:5120
    buffer_load_dwordx4 v3, s[16:19], s74 offen offset:1024 lds
    s_add_u32 s68, s68, 8192
    s_cmp_ge_u32 s68, 409600
    s_cselect_b32 s68, 0, s68
    ds_read_b64_tr_b16 a[56:57], v7 offset:8192
    ds_read_b64_tr_b16 a[58:59], v7 offset:9216
    s_add_u32 m0, s69, 90112
    s_add_u32 s74, s68, s73
    buffer_load_dwordx4 v3, s[16:19], s74 offen offset:0 lds
    ds_read_b64_tr_b16 a[60:61], v7 offset:12288
    ds_read_b64_tr_b16 a[62:63], v7 offset:13312
    buffer_load_dwordx4 v3, s[16:19], s74 offen offset:1024 lds
    s_add_u32 s68, s68, 8192
    s_cmp_ge_u32 s68, 409600
    s_cselect_b32 s68, 0, s68
    s_waitcnt vmcnt(16)
    s_waitcnt lgkmcnt(0)
    s_barrier
    ds_read_b64_tr_b16 a[64:65], v7 offset:16384
    ds_read_b64_tr_b16 a[66:67], v7 offset:17408
    s_add_u32 m0, s69, 0
    s_add_u32 s74, s68, s73
    buffer_load_dwordx4 v3, s[16:19], s74 offen offset:0 lds
    ds_read_b64_tr_b16 a[68:69], v7 offset:20480
    ds_read_b64_tr_b16 a[70:71], v7 offset:21504
    buffer_load_dwordx4 v3, s[16:19], s74 offen offset:1024 lds
    s_add_u32 s68, s68, 8192
    s_cmp_ge_u32 s68, 409600
    s_cselect_b32 s68, 0, s68
    ds_read_b64_tr_b16 a[72:73], v7 offset:24576
    ds_read_b64_tr_b16 a[74:75], v7 offset:25600
    s_add_u32 m0, s69, 8192
    s_add_u32 s74, s68, s73
    buffer_load_dwordx4 v3, s[16:19], s74 offen offset:0 lds
    ds_read_b64_tr_b16 a[76:77], v7 offset:28672
    ds_read_b64_tr_b16 a[78:79], v7 offset:29696
    buffer_load_dwordx4 v3, s[16:19], s74 offen offset:1024 lds
    s_add_u32 s68, s68, 8192
    s_cmp_ge_u32 s68, 409600
    s_cselect_b32 s68, 0, s68
    s_waitcnt vmcnt(16)
    s_waitcnt lgkmcnt(0)
    s_barrier
    ds_read_b64_tr_b16 a[80:81], v7 offset:32768
    ds_read_b64_tr_b16 a[82:83], v7 offset:33792
    s_add_u32 m0, s69, 16384
    s_add_u32 s74, s68, s73
    buffer_load_dwordx4 v3, s[16:19], s74 offen offset:0 lds
    ds_read_b64_tr_b16 a[84:85], v7 offset:36864
    ds_read_b64_tr_b16 a[86:87], v7 offset:37888
    buffer_load_dwordx4 v3, s[16:19], s74 offen offset:1024 lds
    s_add_u32 s68, s68, 8192
    s_cmp_ge_u32 s68, 409600
    s_cselect_b32 s68, 0, s68
    ds_read_b64_tr_b16 a[88:89], v7 offset:40960
    ds_read_b64_tr_b16 a[90:91], v7 offset:41984
    s_add_u32 m0, s69, 24576
    s_add_u32 s74, s68, s73
    buffer_load_dwordx4 v3, s[16:19], s74 offen offset:0 lds
    ds_read_b64_tr_b16 a[92:93], v7 offset:45056
    ds_read_b64_tr_b16 a[94:95], v7 offset:46080
    buffer_load_dwordx4 v3, s[16:19], s74 offen offset:1024 lds
    s_add_u32 s68, s68, 8192
    s_cmp_ge_u32 s68, 409600
    s_cselect_b32 s68, 0, s68
    s_waitcnt vmcnt(16)
    s_waitcnt lgkmcnt(0)
    s_barrier
    ds_read_b64_tr_b16 a[96:97], v7 offset:49152
    ds_read_b64_tr_b16 a[98:99], v7 offset:50176
    s_add_u32 m0, s69, 32768
    s_add_u32 s74, s68, s73
    buffer_load_dwordx4 v3, s[16:19], s74 offen offset:0 lds
    ds_read_b64_tr_b16 a[100:101], v7 offset:53248
    ds_read_b64_tr_b16 a[102:103], v7 offset:54272
    buffer_load_dwordx4 v3, s[16:19], s74 offen offset:1024 lds
    s_add_u32 s68, s68, 8192
    s_cmp_ge_u32 s68, 409600
    s_cselect_b32 s68, 0, s68
    ds_read_b64_tr_b16 a[104:105], v7 offset:57344
    ds_read_b64_tr_b16 a[106:107], v7 offset:58368
    s_add_u32 m0, s69, 40960
    s_add_u32 s74, s68, s73
    buffer_load_dwordx4 v3, s[16:19], s74 offen offset:0 lds
    ds_read_b64_tr_b16 a[108:109], v7 offset:61440
    ds_read_b64_tr_b16 a[110:111], v7 offset:62464
    buffer_load_dwordx4 v3, s[16:19], s74 offen offset:1024 lds
    s_add_u32 s68, s68, 8192
    s_cmp_ge_u32 s68, 409600
    s_cselect_b32 s68, 0, s68
    s_waitcnt vmcnt(16)
    s_waitcnt lgkmcnt(0)
    s_barrier
    ds_read_b64_tr_b16 a[112:113], v13 offset:0
    ds_read_b64_tr_b16 a[114:115], v13 offset:1024
    s_add_u32 m0, s69, 49152
    s_add_u32 s74, s68, s73
    buffer_load_dwordx4 v3, s[16:19], s74 offen offset:0 lds
    ds_read_b64_tr_b16 a[116:117], v13 offset:4096
    ds_read_b64_tr_b16 a[118:119], v13 offset:5120
    buffer_load_dwordx4 v3, s[16:19], s74 offen offset:1024 lds
    s_add_u32 s68, s68, 8192
    s_cmp_ge_u32 s68, 409600
    s_cselect_b32 s68, 0, s68
    ds_read_b64_tr_b16 a[120:121], v13 offset:8192
    ds_read_b64_tr_b16 a[122:123], v13 offset:9216
    s_add_u32 m0, s69, 57344
    s_add_u32 s74, s68, s73
    buffer_load_dwordx4 v3, s[16:19], s74 offen offset:0 lds
    ds_read_b64_tr_b16 a[124:125], v13 offset:12288
    ds_read_b64_tr_b16 a[126:127], v13 offset:13312
    buffer_load_dwordx4 v3, s[16:19], s74 offen offset:1024 lds
    s_add_u32 s68, s68, 8192
    s_cmp_ge_u32 s68, 409600
    s_cselect_b32 s68, 0, s68
    s_waitcnt vmcnt(16)
    s_waitcnt lgkmcnt(0)
    s_barrier
    ds_read_b64_tr_b16 a[128:129], v13 offset:16384
    ds_read_b64_tr_b16 a[130:131], v13 offset:17408
    s_add_u32 m0, s69, 65536
    s_add_u32 s74, s68, s73
    buffer_load_dwordx4 v3, s[16:19], s74 offen offset:0 lds
    ds_read_b64_tr_b16 a[132:133], v13 offset:20480
    ds_read_b64_tr_b16 a[134:135], v13 offset:21504
    buffer_load_dwordx4 v3, s[16:19], s74 offen offset:1024 lds
    s_add_u32 s68, s68, 8192
    s_cmp_ge_u32 s68, 409600
    s_cselect_b32 s68, 0, s68
    ds_read_b64_tr_b16 a[136:137], v13 offset:24576
    ds_read_b64_tr_b16 a[138:139], v13 offset:25600
    s_add_u32 m0, s69, 73728
    s_add_u32 s74, s68, s73
    buffer_load_dwordx4 v3, s[16:19], s74 offen offset:0 lds
    ds_read_b64_tr_b16 a[140:141], v13 offset:28672
    ds_read_b64_tr_b16 a[142:143], v13 offset:29696
    buffer_load_dwordx4 v3, s[16:19], s74 offen offset:1024 lds
    s_add_u32 s68, s68, 8192
    s_cmp_ge_u32 s68, 409600
    s_cselect_b32 s68, 0, s68
    s_waitcnt vmcnt(16)
    s_waitcnt lgkmcnt(0)
    s_barrier
    ds_read_b64_tr_b16 a[144:145], v7 offset:0
    ds_read_b64_tr_b16 a[146:147], v7 offset:1024
    s_add_u32 m0, s69, 81920
    s_add_u32 s74, s68, s73
    buffer_load_dwordx4 v3, s[16:19], s74 offen offset:0 lds
    ds_read_b64_tr_b16 a[148:149], v7 offset:4096
    ds_read_b64_tr_b16 a[150:151], v7 offset:5120
    buffer_load_dwordx4 v3, s[16:19], s74 offen offset:1024 lds
    s_add_u32 s68, s68, 8192
    s_cmp_ge_u32 s68, 409600
    s_cselect_b32 s68, 0, s68
    ds_read_b64_tr_b16 a[152:153], v7 offset:8192
    ds_read_b64_tr_b16 a[154:155], v7 offset:9216
    s_add_u32 m0, s69, 90112
    s_add_u32 s74, s68, s73
    buffer_load_dwordx4 v3, s[16:19], s74 offen offset:0 lds
    ds_read_b64_tr_b16 a[156:157], v7 offset:12288
    ds_read_b64_tr_b16 a[158:159], v7 offset:13312
    buffer_load_dwordx4 v3, s[16:19], s74 offen offset:1024 lds
    s_add_u32 s68, s68, 8192
    s_cmp_ge_u32 s68, 409600
    s_cselect_b32 s68, 0, s68
    s_waitcnt vmcnt(16)
    s_waitcnt lgkmcnt(0)
    s_barrier
    ds_read_b64_tr_b16 a[160:161], v7 offset:16384
    ds_read_b64_tr_b16 a[162:163], v7 offset:17408
    s_add_u32 m0, s69, 0
    s_add_u32 s74, s68, s73
    buffer_load_dwordx4 v3, s[16:19], s74 offen offset:0 lds
    ds_read_b64_tr_b16 a[164:165], v7 offset:20480
    ds_read_b64_tr_b16 a[166:167], v7 offset:21504
    buffer_load_dwordx4 v3, s[16:19], s74 offen offset:1024 lds
    s_add_u32 s68, s68, 8192
    s_cmp_ge_u32 s68, 409600
    s_cselect_b32 s68, 0, s68
    ds_read_b64_tr_b16 a[168:169], v7 offset:24576
    ds_read_b64_tr_b16 a[170:171], v7 offset:25600
    s_add_u32 m0, s69, 8192
    s_add_u32 s74, s68, s73
    buffer_load_dwordx4 v3, s[16:19], s74 offen offset:0 lds
    ds_read_b64_tr_b16 a[172:173], v7 offset:28672
    ds_read_b64_tr_b16 a[174:175], v7 offset:29696
    buffer_load_dwordx4 v3, s[16:19], s74 offen offset:1024 lds
    s_add_u32 s68, s68, 8192
    s_cmp_ge_u32 s68, 409600
    s_cselect_b32 s68, 0, s68
    v_add_u32 v12, s66, v4
    ds_read_b64 v[16:17], v12 offset:0
    s_add_u32 s66, s66, 8
    s_cmp_ge_u32 s66, 200
    s_cselect_b32 s66, 0, s66
    v_add_u32 v12, s66, v4
    ds_read_b64 v[18:19], v12 offset:0
    s_add_u32 s66, s66, 8
    s_cmp_ge_u32 s66, 200
    s_cselect_b32 s66, 0, s66
    v_add_u32 v12, s66, v4
    ds_read_b64 v[20:21], v12 offset:0
    s_add_u32 s66, s66, 8
    s_cmp_ge_u32 s66, 200
    s_cselect_b32 s66, 0, s66
    v_add_u32 v12, s66, v4
    ds_read_b64 v[22:23], v12 offset:0
    s_add_u32 s66, s66, 8
    s_cmp_ge_u32 s66, 200
    s_cselect_b32 s66, 0, s66
    s_waitcnt lgkmcnt(0)
    v_lshl_add_u32 v16, v16, 6, v2
    s_add_u32 m0, s70, 98304
    s_nop 0
    buffer_load_dwordx4 v16, s[12:15], 0 offen lds
    v_lshl_add_u32 v17, v17, 6, v2
    s_add_u32 m0, s70, 102400
    s_nop 0
    buffer_load_dwordx4 v17, s[12:15], 0 offen lds
    v_lshl_add_u32 v18, v18, 6, v2
    s_add_u32 m0, s70, 106496
    s_nop 0
    buffer_load_dwordx4 v18, s[12:15], 0 offen lds
    v_lshl_add_u32 v19, v19, 6, v2
    s_add_u32 m0, s70, 110592
    s_nop 0
    buffer_load_dwordx4 v19, s[12:15], 0 offen lds
    v_lshl_add_u32 v20, v20, 6, v2
    s_add_u32 m0, s70, 114688
    s_nop 0
    buffer_load_dwordx4 v20, s[12:15], 0 offen lds
    v_lshl_add_u32 v21, v21, 6, v2
    s_add_u32 m0, s70, 118784
    s_nop 0
    buffer_load_dwordx4 v21, s[12:15], 0 offen lds
    v_lshl_add_u32 v22, v22, 6, v2
    s_add_u32 m0, s70, 122880
    s_nop 0
    buffer_load_dwordx4 v22, s[12:15], 0 offen lds
    v_lshl_add_u32 v23, v23, 6, v2
    s_add_u32 m0, s70, 126976
    s_nop 0
    buffer_load_dwordx4 v23, s[12:15], 0 offen lds
    s_waitcnt vmcnt(24)
    s_barrier
    ds_read_b64_tr_b16 a[176:177], v7 offset:32768
    ds_read_b64_tr_b16 a[178:179], v7 offset:33792
    ds_read_b64_tr_b16 a[180:181], v7 offset:36864
    ds_read_b64_tr_b16 a[182:183], v7 offset:37888
    ds_read_b64_tr_b16 a[184:185], v7 offset:40960
    ds_read_b64_tr_b16 a[186:187], v7 offset:41984
    ds_read_b64_tr_b16 a[188:189], v7 offset:45056
    ds_read_b64_tr_b16 a[190:191], v7 offset:46080
    s_waitcnt vmcnt(20)
    s_waitcnt lgkmcnt(0)
    s_barrier
    ds_read_b64_tr_b16 a[192:193], v7 offset:49152
    ds_read_b64_tr_b16 a[194:195], v7 offset:50176
    ds_read_b64_tr_b16 a[196:197], v7 offset:53248
    ds_read_b64_tr_b16 a[198:199], v7 offset:54272
    ds_read_b64_tr_b16 a[200:201], v7 offset:57344
    ds_read_b64_tr_b16 a[202:203], v7 offset:58368
    ds_read_b64_tr_b16 a[204:205], v7 offset:61440
    ds_read_b64_tr_b16 a[206:207], v7 offset:62464
    s_waitcnt vmcnt(16)
    s_waitcnt lgkmcnt(0)
    s_barrier
    ds_read_b64_tr_b16 a[208:209], v13 offset:0
    ds_read_b64_tr_b16 a[210:211], v13 offset:1024
    ds_read_b64_tr_b16 a[212:213], v13 offset:4096
    ds_read_b64_tr_b16 a[214:215], v13 offset:5120
    ds_read_b64_tr_b16 a[216:217], v13 offset:8192
    ds_read_b64_tr_b16 a[218:219], v13 offset:9216
    ds_read_b64_tr_b16 a[220:221], v13 offset:12288
    ds_read_b64_tr_b16 a[222:223], v13 offset:13312
    s_waitcnt vmcnt(12)
    s_waitcnt lgkmcnt(0)
    s_barrier
    ds_read_b64_tr_b16 a[224:225], v13 offset:16384
    ds_read_b64_tr_b16 a[226:227], v13 offset:17408
    ds_read_b64_tr_b16 a[228:229], v13 offset:20480
    ds_read_b64_tr_b16 a[230:231], v13 offset:21504
    ds_read_b64_tr_b16 a[232:233], v13 offset:24576
    ds_read_b64_tr_b16 a[234:235], v13 offset:25600
    ds_read_b64_tr_b16 a[236:237], v13 offset:28672
    ds_read_b64_tr_b16 a[238:239], v13 offset:29696
    s_waitcnt vmcnt(8)
    s_waitcnt lgkmcnt(0)
    s_barrier
    ds_read_b64_tr_b16 a[240:241], v7 offset:0
    ds_read_b64_tr_b16 a[242:243], v7 offset:1024
    ds_read_b64_tr_b16 a[244:245], v7 offset:4096
    ds_read_b64_tr_b16 a[246:247], v7 offset:5120
    ds_read_b64_tr_b16 a[248:249], v7 offset:8192
    ds_read_b64_tr_b16 a[250:251], v7 offset:9216
    ds_read_b64_tr_b16 a[252:253], v7 offset:12288
    ds_read_b64_tr_b16 a[254:255], v7 offset:13312
    s_waitcnt lgkmcnt(0)
    s_barrier
    v_add_u32 v12, s66, v4
    ds_read_b64 v[16:17], v12 offset:0
    s_add_u32 s66, s66, 8
    s_cmp_ge_u32 s66, 200
    s_cselect_b32 s66, 0, s66
    s_waitcnt lgkmcnt(0)
    v_lshl_add_u32 v16, v16, 6, v2
    s_add_u32 m0, s70, 81920
    s_nop 0
    buffer_load_dwordx4 v16, s[12:15], 0 offen lds
    v_lshl_add_u32 v17, v17, 6, v2
    s_add_u32 m0, s70, 86016
    s_nop 0
    buffer_load_dwordx4 v17, s[12:15], 0 offen lds
    s_waitcnt vmcnt(9)
    s_barrier
    ds_read_b128 v[16:19], v5 offset:16384
    ds_read_b128 v[20:23], v5 offset:18432
    ds_read_b128 v[24:27], v6 offset:16384
    ds_read_b128 v[28:31], v6 offset:18432
    v_add_u32 v13, s66, v4
    ds_read_b64 v[8:9], v13 offset:0
    s_add_u32 s66, s66, 8
    s_cmp_ge_u32 s66, 200
    s_cselect_b32 s66, 0, s66
    s_waitcnt vmcnt(7)
    s_barrier
    s_waitcnt lgkmcnt(1)
    v_mfma_f32_32x32x16_bf16 v[48:63], v[112:115], v[16:19], 0
    ds_read_b128 v[32:35], v5 offset:20480
    ds_read_b128 v[36:39], v5 offset:22528
    ds_read_b128 v[40:43], v6 offset:20480
    ds_read_b128 v[44:47], v6 offset:22528
    v_mfma_f32_32x32x16_bf16 v[64:79], v[112:115], v[20:23], 0
    s_waitcnt lgkmcnt(4)
    v_lshl_add_u32 v8, v8, 6, v2
    s_add_u32 m0, s70, 90112
    s_nop 0
    buffer_load_dwordx4 v8, s[12:15], 0 offen lds
    v_mfma_f32_32x32x16_bf16 v[48:63], v[116:119], v[24:27], v[48:63]
    v_mfma_f32_32x32x16_bf16 v[64:79], v[116:119], v[28:31], v[64:79]
    s_lshl_b32 s101, s2, 8
    s_add_u32 s101, s101, 4194304
    s_xor_b32 s3, s2, 8
    s_lshl_b32 s3, s3, 8
    s_add_u32 s3, s3, 4194304
    v_mov_b32 v12, 0
    buffer_load_dword v15, v12, s[32:35], s101 offen sc1
    buffer_load_dword v92, v12, s[32:35], s3 offen sc1
    s_waitcnt lgkmcnt(0)
    v_mfma_f32_32x32x16_bf16 v[48:63], v[120:123], v[32:35], v[48:63]
    ds_read_b128 v[16:19], v5 offset:24576
    ds_read_b128 v[20:23], v5 offset:26624
    ds_read_b128 v[24:27], v6 offset:24576
    ds_read_b128 v[28:31], v6 offset:26624
    v_mfma_f32_32x32x16_bf16 v[64:79], v[120:123], v[36:39], v[64:79]
    v_lshl_add_u32 v9, v9, 6, v2
    s_add_u32 m0, s70, 94208
    s_nop 0
    buffer_load_dwordx4 v9, s[12:15], 0 offen lds
    v_mfma_f32_32x32x16_bf16 v[48:63], v[124:127], v[40:43], v[48:63]
    v_mfma_f32_32x32x16_bf16 v[64:79], v[124:127], v[44:47], v[64:79]
    v_add_u32 v13, s66, v4
    ds_read_b64 v[8:9], v13 offset:0
    s_add_u32 s66, s66, 8
    s_cmp_ge_u32 s66, 200
    s_cselect_b32 s66, 0, s66
    s_waitcnt vmcnt(9)
    s_barrier
    s_waitcnt lgkmcnt(1)
    v_mfma_f32_32x32x16_bf16 v[48:63], v[128:131], v[16:19], v[48:63]
    ds_read_b128 v[32:35], v5 offset:28672
    ds_read_b128 v[36:39], v5 offset:30720
    ds_read_b128 v[40:43], v6 offset:28672
    ds_read_b128 v[44:47], v6 offset:30720
    v_mfma_f32_32x32x16_bf16 v[64:79], v[128:131], v[20:23], v[64:79]
    s_waitcnt lgkmcnt(4)
    v_lshl_add_u32 v8, v8, 6, v2
    s_add_u32 m0, s70, 98304
    s_nop 0
    buffer_load_dwordx4 v8, s[12:15], 0 offen lds
    v_mfma_f32_32x32x16_bf16 v[48:63], v[132:135], v[24:27], v[48:63]
    v_mfma_f32_32x32x16_bf16 v[64:79], v[132:135], v[28:31], v[64:79]
    v_lshlrev_b32 v12, 4, v1
    s_cmp_lt_u32 s64, 2
    s_cselect_b32 s20, s40, s48
    s_cselect_b32 s21, s41, s49
    s_mov_b32 s22, 256
    s_cselect_b32 s22, 425984, s22
    s_cmp_eq_u32 s64, 3
    s_cselect_b32 s20, s50, s20
    s_cselect_b32 s21, s51, s21
    s_and_b32 s21, s21, 0xffff
    s_mov_b32 s23, 0x20000
    s_mul_i32 s71, s75, 26
    s_add_u32 s71, s71, s70
    s_cmp_lt_u32 s64, 2
    s_cselect_b32 s71, s71, 0
    s_add_u32 m0, s70, 157696
    s_nop 0
    buffer_load_dwordx4 v12, s[20:23], s71 offen lds
    v_lshlrev_b32 v88, 1, v1
    s_mov_b32 s28, s42
    s_and_b32 s29, s43, 0xffff
    s_mov_b32 s30, 26
    s_mov_b32 s31, 0x20000
    buffer_load_ushort v89, v88, s[28:31], 0 offen
    s_nop 0
    s_mov_b32 s28, s44
    s_and_b32 s29, s45, 0xffff
    s_mov_b32 s30, 2
    s_mov_b32 s31, 0x20000
    buffer_load_ushort v90, v88, s[28:31], 0 offen
    s_nop 0
    s_mov_b32 s28, s52
    s_and_b32 s29, s53, 0xffff
    s_mov_b32 s30, 2
    s_mov_b32 s31, 0x20000
    buffer_load_ushort v91, v88, s[28:31], 0 offen
    s_nop 0
    s_waitcnt lgkmcnt(0)
    v_mfma_f32_32x32x16_bf16 v[48:63], v[136:139], v[32:35], v[48:63]
    ds_read_b128 v[16:19], v5 offset:32768
    ds_read_b128 v[20:23], v5 offset:34816
    ds_read_b128 v[24:27], v6 offset:32768
    ds_read_b128 v[28:31], v6 offset:34816
    v_mfma_f32_32x32x16_bf16 v[64:79], v[136:139], v[36:39], v[64:79]
    v_lshl_add_u32 v9, v9, 6, v2
    s_add_u32 m0, s70, 102400
    s_nop 0
    buffer_load_dwordx4 v9, s[12:15], 0 offen lds
    v_mfma_f32_32x32x16_bf16 v[48:63], v[140:143], v[40:43], v[48:63]
    v_mfma_f32_32x32x16_bf16 v[64:79], v[140:143], v[44:47], v[64:79]
    v_add_u32 v13, s66, v4
    ds_read_b64 v[8:9], v13 offset:0
    s_add_u32 s66, s66, 8
    s_cmp_ge_u32 s66, 200
    s_cselect_b32 s66, 0, s66
    s_waitcnt vmcnt(13)
    s_barrier
    s_waitcnt lgkmcnt(1)
    v_mfma_f32_32x32x16_bf16 v[48:63], v[144:147], v[16:19], v[48:63]
    ds_read_b128 v[32:35], v5 offset:36864
    ds_read_b128 v[36:39], v5 offset:38912
    ds_read_b128 v[40:43], v6 offset:36864
    ds_read_b128 v[44:47], v6 offset:38912
    v_mfma_f32_32x32x16_bf16 v[64:79], v[144:147], v[20:23], v[64:79]
    s_waitcnt lgkmcnt(4)
    v_lshl_add_u32 v8, v8, 6, v2
    s_add_u32 m0, s70, 106496
    s_nop 0
    buffer_load_dwordx4 v8, s[12:15], 0 offen lds
    v_mfma_f32_32x32x16_bf16 v[48:63], v[148:151], v[24:27], v[48:63]
    v_mfma_f32_32x32x16_bf16 v[64:79], v[148:151], v[28:31], v[64:79]
    s_waitcnt lgkmcnt(0)
    v_mfma_f32_32x32x16_bf16 v[48:63], v[152:155], v[32:35], v[48:63]
    ds_read_b128 v[16:19], v5 offset:40960
    ds_read_b128 v[20:23], v5 offset:43008
    ds_read_b128 v[24:27], v6 offset:40960
    ds_read_b128 v[28:31], v6 offset:43008
    v_mfma_f32_32x32x16_bf16 v[64:79], v[152:155], v[36:39], v[64:79]
    v_lshl_add_u32 v9, v9, 6, v2
    s_add_u32 m0, s70, 110592
    s_nop 0
    buffer_load_dwordx4 v9, s[12:15], 0 offen lds
    v_mfma_f32_32x32x16_bf16 v[48:63], v[156:159], v[40:43], v[48:63]
    v_mfma_f32_32x32x16_bf16 v[64:79], v[156:159], v[44:47], v[64:79]
    v_add_u32 v13, s66, v4
    ds_read_b64 v[8:9], v13 offset:0
    s_add_u32 s66, s66, 8
    s_cmp_ge_u32 s66, 200
    s_cselect_b32 s66, 0, s66
    s_waitcnt vmcnt(13)
    s_barrier
    s_waitcnt lgkmcnt(1)
    v_mfma_f32_32x32x16_bf16 v[48:63], v[160:163], v[16:19], v[48:63]
    ds_read_b128 v[32:35], v5 offset:45056
    ds_read_b128 v[36:39], v5 offset:47104
    ds_read_b128 v[40:43], v6 offset:45056
    ds_read_b128 v[44:47], v6 offset:47104
    v_mfma_f32_32x32x16_bf16 v[64:79], v[160:163], v[20:23], v[64:79]
    s_waitcnt lgkmcnt(4)
    v_lshl_add_u32 v8, v8, 6, v2
    s_add_u32 m0, s70, 114688
    s_nop 0
    buffer_load_dwordx4 v8, s[12:15], 0 offen lds
    v_mfma_f32_32x32x16_bf16 v[48:63], v[164:167], v[24:27], v[48:63]
    v_mfma_f32_32x32x16_bf16 v[64:79], v[164:167], v[28:31], v[64:79]
    s_waitcnt lgkmcnt(0)
    v_mfma_f32_32x32x16_bf16 v[48:63], v[168:171], v[32:35], v[48:63]
    ds_read_b128 v[16:19], v5 offset:0
    ds_read_b128 v[20:23], v5 offset:2048
    ds_read_b128 v[24:27], v6 offset:0
    ds_read_b128 v[28:31], v6 offset:2048
    v_mfma_f32_32x32x16_bf16 v[64:79], v[168:171], v[36:39], v[64:79]
    v_lshl_add_u32 v9, v9, 6, v2
    s_add_u32 m0, s70, 118784
    s_nop 0
    buffer_load_dwordx4 v9, s[12:15], 0 offen lds
    v_mfma_f32_32x32x16_bf16 v[48:63], v[172:175], v[40:43], v[48:63]
    v_mfma_f32_32x32x16_bf16 v[64:79], v[172:175], v[44:47], v[64:79]
    v_add_u32 v13, s66, v4
    ds_read_b64 v[8:9], v13 offset:0
    s_add_u32 s66, s66, 8
    s_cmp_ge_u32 s66, 200
    s_cselect_b32 s66, 0, s66
    s_waitcnt vmcnt(13)
    s_barrier
    s_waitcnt lgkmcnt(1)
    v_mfma_f32_32x32x16_bf16 v[48:63], v[176:179], v[16:19], v[48:63]
    ds_read_b128 v[32:35], v5 offset:4096
    ds_read_b128 v[36:39], v5 offset:6144
    ds_read_b128 v[40:43], v6 offset:4096
    ds_read_b128 v[44:47], v6 offset:6144
    v_mfma_f32_32x32x16_bf16 v[64:79], v[176:179], v[20:23], v[64:79]
    s_waitcnt lgkmcnt(4)
    v_lshl_add_u32 v8, v8, 6, v2
    s_add_u32 m0, s70, 122880
    s_nop 0
    buffer_load_dwordx4 v8, s[12:15], 0 offen lds
    v_mfma_f32_32x32x16_bf16 v[48:63], v[180:183], v[24:27], v[48:63]
    v_mfma_f32_32x32x16_bf16 v[64:79], v[180:183], v[28:31], v[64:79]
    s_waitcnt lgkmcnt(0)
    v_mfma_f32_32x32x16_bf16 v[48:63], v[184:187], v[32:35], v[48:63]
    ds_read_b128 v[16:19], v5 offset:8192
    ds_read_b128 v[20:23], v5 offset:10240
    ds_read_b128 v[24:27], v6 offset:8192
    ds_read_b128 v[28:31], v6 offset:10240
    v_mfma_f32_32x32x16_bf16 v[64:79], v[184:187], v[36:39], v[64:79]
    v_lshl_add_u32 v9, v9, 6, v2
    s_add_u32 m0, s70, 126976
    s_nop 0
    buffer_load_dwordx4 v9, s[12:15], 0 offen lds
    v_mfma_f32_32x32x16_bf16 v[48:63], v[188:191], v[40:43], v[48:63]
    v_mfma_f32_32x32x16_bf16 v[64:79], v[188:191], v[44:47], v[64:79]
    v_add_u32 v13, s66, v4
    ds_read_b64 v[8:9], v13 offset:0
    s_add_u32 s66, s66, 8
    s_cmp_ge_u32 s66, 200
    s_cselect_b32 s66, 0, s66
    s_waitcnt vmcnt(11)
    s_barrier
    s_waitcnt lgkmcnt(1)
    v_mfma_f32_32x32x16_bf16 v[48:63], v[192:195], v[16:19], v[48:63]
    ds_read_b128 v[32:35], v5 offset:12288
    ds_read_b128 v[36:39], v5 offset:14336
    ds_read_b128 v[40:43], v6 offset:12288
    ds_read_b128 v[44:47], v6 offset:14336
    v_mfma_f32_32x32x16_bf16 v[64:79], v[192:195], v[20:23], v[64:79]
    s_waitcnt lgkmcnt(4)
    v_lshl_add_u32 v8, v8, 6, v2
    s_add_u32 m0, s70, 81920
    s_nop 0
    buffer_load_dwordx4 v8, s[12:15], 0 offen lds
    v_mfma_f32_32x32x16_bf16 v[48:63], v[196:199], v[24:27], v[48:63]
    v_mfma_f32_32x32x16_bf16 v[64:79], v[196:199], v[28:31], v[64:79]
    v_readfirstlane_b32 s79, v15
    v_readfirstlane_b32 s100, v92
    s_nop 1
    s_add_u32 s79, s79, 1
    s_add_u32 s100, s100, 1
    v_mov_b32 v15, s100
    v_mov_b32 v12, 0
    s_cmp_eq_u32 s64, 0
    s_cselect_b32 s71, 1, 0
    s_mov_b32 exec_hi, 0
    s_mov_b32 exec_lo, s71
    buffer_store_dword v15, v12, s[32:35], s101 offen offset:128 sc1
    s_mov_b64 exec, -1
    s_nop 3
    s_waitcnt lgkmcnt(0)
    v_mfma_f32_32x32x16_bf16 v[48:63], v[200:203], v[32:35], v[48:63]
    ds_read_b128 v[16:19], v5 offset:16384
    ds_read_b128 v[20:23], v5 offset:18432
    ds_read_b128 v[24:27], v6 offset:16384
    ds_read_b128 v[28:31], v6 offset:18432
    v_mfma_f32_32x32x16_bf16 v[64:79], v[200:203], v[36:39], v[64:79]
    v_lshl_add_u32 v9, v9, 6, v2
    s_add_u32 m0, s70, 86016
    s_nop 0
    buffer_load_dwordx4 v9, s[12:15], 0 offen lds
    v_mfma_f32_32x32x16_bf16 v[48:63], v[204:207], v[40:43], v[48:63]
    v_mfma_f32_32x32x16_bf16 v[64:79], v[204:207], v[44:47], v[64:79]
    v_add_u32 v13, s66, v4
    ds_read_b64 v[8:9], v13 offset:0
    s_add_u32 s66, s66, 8
    s_cmp_ge_u32 s66, 200
    s_cselect_b32 s66, 0, s66
    s_waitcnt vmcnt(8)
    s_barrier
    s_waitcnt lgkmcnt(1)
    v_mfma_f32_32x32x16_bf16 v[48:63], v[208:211], v[16:19], v[48:63]
    ds_read_b128 v[32:35], v5 offset:20480
    ds_read_b128 v[36:39], v5 offset:22528
    ds_read_b128 v[40:43], v6 offset:20480
    ds_read_b128 v[44:47], v6 offset:22528
    v_mfma_f32_32x32x16_bf16 v[64:79], v[208:211], v[20:23], v[64:79]
    s_waitcnt lgkmcnt(4)
    v_lshl_add_u32 v8, v8, 6, v2
    s_add_u32 m0, s70, 90112
    s_nop 0
    buffer_load_dwordx4 v8, s[12:15], 0 offen lds
    v_mfma_f32_32x32x16_bf16 v[48:63], v[212:215], v[24:27], v[48:63]
    v_mfma_f32_32x32x16_bf16 v[64:79], v[212:215], v[28:31], v[64:79]
    s_waitcnt lgkmcnt(0)
    v_mfma_f32_32x32x16_bf16 v[48:63], v[216:219], v[32:35], v[48:63]
    ds_read_b128 v[16:19], v5 offset:24576
    ds_read_b128 v[20:23], v5 offset:26624
    ds_read_b128 v[24:27], v6 offset:24576
    ds_read_b128 v[28:31], v6 offset:26624
    v_mfma_f32_32x32x16_bf16 v[64:79], v[216:219], v[36:39], v[64:79]
    v_lshl_add_u32 v9, v9, 6, v2
    s_add_u32 m0, s70, 94208
    s_nop 0
    buffer_load_dwordx4 v9, s[12:15], 0 offen lds
    v_mfma_f32_32x32x16_bf16 v[48:63], v[220:223], v[40:43], v[48:63]
    v_mfma_f32_32x32x16_bf16 v[64:79], v[220:223], v[44:47], v[64:79]
    v_add_u32 v13, s66, v4
    ds_read_b64 v[8:9], v13 offset:0
    s_add_u32 s66, s66, 8
    s_cmp_ge_u32 s66, 200
    s_cselect_b32 s66, 0, s66
    s_waitcnt vmcnt(8)
    s_barrier
    s_waitcnt lgkmcnt(1)
    v_mfma_f32_32x32x16_bf16 v[48:63], v[224:227], v[16:19], v[48:63]
    ds_read_b128 v[32:35], v5 offset:28672
    ds_read_b128 v[36:39], v5 offset:30720
    ds_read_b128 v[40:43], v6 offset:28672
    ds_read_b128 v[44:47], v6 offset:30720
    v_mfma_f32_32x32x16_bf16 v[64:79], v[224:227], v[20:23], v[64:79]
    s_waitcnt lgkmcnt(4)
    v_lshl_add_u32 v8, v8, 6, v2
    s_add_u32 m0, s70, 98304
    s_nop 0
    buffer_load_dwordx4 v8, s[12:15], 0 offen lds
    v_mfma_f32_32x32x16_bf16 v[48:63], v[228:231], v[24:27], v[48:63]
    v_mfma_f32_32x32x16_bf16 v[64:79], v[228:231], v[28:31], v[64:79]
    s_waitcnt lgkmcnt(0)
    v_mfma_f32_32x32x16_bf16 v[48:63], v[232:235], v[32:35], v[48:63]
    ds_read_b128 v[16:19], v5 offset:32768
    ds_read_b128 v[20:23], v5 offset:34816
    ds_read_b128 v[24:27], v6 offset:32768
    ds_read_b128 v[28:31], v6 offset:34816
    v_mfma_f32_32x32x16_bf16 v[64:79], v[232:235], v[36:39], v[64:79]
    v_lshl_add_u32 v9, v9, 6, v2
    s_add_u32 m0, s70, 102400
    s_nop 0
    buffer_load_dwordx4 v9, s[12:15], 0 offen lds
    v_mfma_f32_32x32x16_bf16 v[48:63], v[236:239], v[40:43], v[48:63]
    v_mfma_f32_32x32x16_bf16 v[64:79], v[236:239], v[44:47], v[64:79]
    v_add_u32 v13, s66, v4
    ds_read_b64 v[8:9], v13 offset:0
    s_add_u32 s66, s66, 8
    s_cmp_ge_u32 s66, 200
    s_cselect_b32 s66, 0, s66
    s_waitcnt vmcnt(8)
    s_barrier
    s_waitcnt lgkmcnt(1)
    v_mfma_f32_32x32x16_bf16 v[48:63], v[240:243], v[16:19], v[48:63]
    ds_read_b128 v[32:35], v5 offset:36864
    ds_read_b128 v[36:39], v5 offset:38912
    ds_read_b128 v[40:43], v6 offset:36864
    ds_read_b128 v[44:47], v6 offset:38912
    v_mfma_f32_32x32x16_bf16 v[64:79], v[240:243], v[20:23], v[64:79]
    s_waitcnt lgkmcnt(4)
    v_lshl_add_u32 v8, v8, 6, v2
    s_add_u32 m0, s70, 106496
    s_nop 0
    buffer_load_dwordx4 v8, s[12:15], 0 offen lds
    v_mfma_f32_32x32x16_bf16 v[48:63], v[244:247], v[24:27], v[48:63]
    v_mfma_f32_32x32x16_bf16 v[64:79], v[244:247], v[28:31], v[64:79]
    s_waitcnt lgkmcnt(0)
    v_mfma_f32_32x32x16_bf16 v[48:63], v[248:251], v[32:35], v[48:63]
    ds_read_b128 v[16:19], v5 offset:40960
    ds_read_b128 v[20:23], v5 offset:43008
    ds_read_b128 v[24:27], v6 offset:40960
    ds_read_b128 v[28:31], v6 offset:43008
    v_mfma_f32_32x32x16_bf16 v[64:79], v[248:251], v[36:39], v[64:79]
    v_lshl_add_u32 v9, v9, 6, v2
    s_add_u32 m0, s70, 110592
    s_nop 0
    buffer_load_dwordx4 v9, s[12:15], 0 offen lds
    v_mfma_f32_32x32x16_bf16 v[48:63], v[252:255], v[40:43], v[48:63]
    v_mfma_f32_32x32x16_bf16 v[64:79], v[252:255], v[44:47], v[64:79]
    v_add_u32 v13, s66, v4
    ds_read_b64 v[8:9], v13 offset:0
    s_add_u32 s66, s66, 8
    s_cmp_ge_u32 s66, 200
    s_cselect_b32 s66, 0, s66
    s_waitcnt vmcnt(8)
    s_barrier
    s_waitcnt lgkmcnt(1)
    v_mfma_f32_32x32x16_bf16 v[48:63], a[0:3], v[16:19], v[48:63]
    ds_read_b128 v[32:35], v5 offset:45056
    ds_read_b128 v[36:39], v5 offset:47104
    ds_read_b128 v[40:43], v6 offset:45056
    ds_read_b128 v[44:47], v6 offset:47104
    v_mfma_f32_32x32x16_bf16 v[64:79], a[0:3], v[20:23], v[64:79]
    s_waitcnt lgkmcnt(4)
    v_lshl_add_u32 v8, v8, 6, v2
    s_add_u32 m0, s70, 114688
    s_nop 0
    buffer_load_dwordx4 v8, s[12:15], 0 offen lds
    v_mfma_f32_32x32x16_bf16 v[48:63], a[4:7], v[24:27], v[48:63]
    v_mfma_f32_32x32x16_bf16 v[64:79], a[4:7], v[28:31], v[64:79]
    v_lshlrev_b32 v89, 16, v89
    v_lshlrev_b32 v90, 16, v90
    v_lshlrev_b32 v91, 16, v91
    s_nop 0
    v_readlane_b32 s80, v89, 0
    v_readlane_b32 s81, v89, 1
    v_readlane_b32 s82, v89, 2
    v_readlane_b32 s83, v89, 3
    v_readlane_b32 s84, v89, 4
    v_readlane_b32 s85, v89, 5
    v_readlane_b32 s86, v89, 6
    v_readlane_b32 s87, v89, 7
    v_readlane_b32 s88, v89, 8
    v_readlane_b32 s89, v89, 9
    v_readlane_b32 s90, v89, 10
    v_readlane_b32 s91, v89, 11
    v_readlane_b32 s92, v89, 12
    v_readlane_b32 s93, v90, 0
    v_readlane_b32 s94, v91, 0
    s_waitcnt lgkmcnt(0)
    v_mfma_f32_32x32x16_bf16 v[48:63], a[8:11], v[32:35], v[48:63]
    ds_read_b128 v[16:19], v5 offset:0
    ds_read_b128 v[20:23], v5 offset:2048
    ds_read_b128 v[24:27], v6 offset:0
    ds_read_b128 v[28:31], v6 offset:2048
    v_mfma_f32_32x32x16_bf16 v[64:79], a[8:11], v[36:39], v[64:79]
    v_lshl_add_u32 v9, v9, 6, v2
    s_add_u32 m0, s70, 118784
    s_nop 0
    buffer_load_dwordx4 v9, s[12:15], 0 offen lds
    v_mfma_f32_32x32x16_bf16 v[48:63], a[12:15], v[40:43], v[48:63]
    v_mfma_f32_32x32x16_bf16 v[64:79], a[12:15], v[44:47], v[64:79]
    v_add_u32 v13, s66, v4
    ds_read_b64 v[8:9], v13 offset:0
    s_add_u32 s66, s66, 8
    s_cmp_ge_u32 s66, 200
    s_cselect_b32 s66, 0, s66
    s_waitcnt vmcnt(7)
    s_barrier
    s_waitcnt lgkmcnt(1)
    v_mfma_f32_32x32x16_bf16 v[48:63], a[16:19], v[16:19], v[48:63]
    ds_read_b128 v[32:35], v5 offset:4096
    ds_read_b128 v[36:39], v5 offset:6144
    ds_read_b128 v[40:43], v6 offset:4096
    ds_read_b128 v[44:47], v6 offset:6144
    v_mfma_f32_32x32x16_bf16 v[64:79], a[16:19], v[20:23], v[64:79]
    s_waitcnt lgkmcnt(4)
    v_lshl_add_u32 v8, v8, 6, v2
    s_add_u32 m0, s70, 122880
    s_nop 0
    buffer_load_dwordx4 v8, s[12:15], 0 offen lds
    v_mfma_f32_32x32x16_bf16 v[48:63], a[20:23], v[24:27], v[48:63]
    v_mfma_f32_32x32x16_bf16 v[64:79], a[20:23], v[28:31], v[64:79]
    v_lshrrev_b32 v12, 5, v1
    v_lshlrev_b32 v12, 3, v12
    s_lshl_b32 s71, s64, 6
    v_add_u32 v12, s71, v12
    v_add_u32 v12, 159744, v12
    ds_read_b64 v[96:97], v12 offset:0
    ds_read_b64 v[98:99], v12 offset:16
    ds_read_b64 v[100:101], v12 offset:32
    ds_read_b64 v[102:103], v12 offset:48
    s_waitcnt lgkmcnt(0)
    v_lshlrev_b32 v80, 16, v96
    v_and_b32 v81, 0xffff0000, v96
    v_lshlrev_b32 v82, 16, v97
    v_and_b32 v83, 0xffff0000, v97
    v_lshlrev_b32 v84, 16, v98
    v_and_b32 v85, 0xffff0000, v98
    v_lshlrev_b32 v86, 16, v99
    v_and_b32 v87, 0xffff0000, v99
    v_lshlrev_b32 v88, 16, v100
    v_and_b32 v89, 0xffff0000, v100
    v_lshlrev_b32 v90, 16, v101
    v_and_b32 v91, 0xffff0000, v101
    v_lshlrev_b32 v92, 16, v102
    v_and_b32 v93, 0xffff0000, v102
    v_lshlrev_b32 v94, 16, v103
    v_and_b32 v95, 0xffff0000, v103
    v_mov_b32 v96, v80
    v_mov_b32 v97, v81
    v_mov_b32 v98, v82
    v_mov_b32 v99, v83
    v_mov_b32 v100, v84
    v_mov_b32 v101, v85
    v_mov_b32 v102, v86
    v_mov_b32 v103, v87
    v_mov_b32 v104, v88
    v_mov_b32 v105, v89
    v_mov_b32 v106, v90
    v_mov_b32 v107, v91
    v_mov_b32 v108, v92
    v_mov_b32 v109, v93
    v_mov_b32 v110, v94
    v_mov_b32 v111, v95
    v_mfma_f32_32x32x16_bf16 v[48:63], a[24:27], v[32:35], v[48:63]
    ds_read_b128 v[16:19], v5 offset:8192
    ds_read_b128 v[20:23], v5 offset:10240
    ds_read_b128 v[24:27], v6 offset:8192
    ds_read_b128 v[28:31], v6 offset:10240
    v_mfma_f32_32x32x16_bf16 v[64:79], a[24:27], v[36:39], v[64:79]
    v_lshl_add_u32 v9, v9, 6, v2
    s_add_u32 m0, s70, 126976
    s_nop 0
    buffer_load_dwordx4 v9, s[12:15], 0 offen lds
    v_mfma_f32_32x32x16_bf16 v[48:63], a[28:31], v[40:43], v[48:63]
    v_mfma_f32_32x32x16_bf16 v[64:79], a[28:31], v[44:47], v[64:79]
    v_add_u32 v13, s66, v4
    ds_read_b64 v[8:9], v13 offset:0
    s_add_u32 s66, s66, 8
    s_cmp_ge_u32 s66, 200
    s_cselect_b32 s66, 0, s66
    s_waitcnt vmcnt(7)
    s_barrier
    s_waitcnt lgkmcnt(1)
    v_mfma_f32_32x32x16_bf16 v[48:63], a[32:35], v[16:19], v[48:63]
    ds_read_b128 v[32:35], v5 offset:12288
    ds_read_b128 v[36:39], v5 offset:14336
    ds_read_b128 v[40:43], v6 offset:12288
    ds_read_b128 v[44:47], v6 offset:14336
    v_mfma_f32_32x32x16_bf16 v[64:79], a[32:35], v[20:23], v[64:79]
    s_waitcnt lgkmcnt(4)
    v_lshl_add_u32 v8, v8, 6, v2
    s_add_u32 m0, s70, 81920
    s_nop 0
    buffer_load_dwordx4 v8, s[12:15], 0 offen lds
    v_mfma_f32_32x32x16_bf16 v[48:63], a[36:39], v[24:27], v[48:63]
    v_mfma_f32_32x32x16_bf16 v[64:79], a[36:39], v[28:31], v[64:79]
    s_waitcnt lgkmcnt(0)
    v_mfma_f32_32x32x16_bf16 v[48:63], a[40:43], v[32:35], v[48:63]
    ds_read_b128 v[16:19], v5 offset:16384
    ds_read_b128 v[20:23], v5 offset:18432
    ds_read_b128 v[24:27], v6 offset:16384
    ds_read_b128 v[28:31], v6 offset:18432
    v_mfma_f32_32x32x16_bf16 v[64:79], a[40:43], v[36:39], v[64:79]
    v_lshl_add_u32 v9, v9, 6, v2
    s_add_u32 m0, s70, 86016
    s_nop 0
    buffer_load_dwordx4 v9, s[12:15], 0 offen lds
    v_mfma_f32_32x32x16_bf16 v[48:63], a[44:47], v[40:43], v[48:63]
    v_mfma_f32_32x32x16_bf16 v[64:79], a[44:47], v[44:47], v[64:79]
    v_add_u32 v13, s66, v4
    ds_read_b64 v[8:9], v13 offset:0
    s_add_u32 s66, s66, 8
    s_cmp_ge_u32 s66, 200
    s_cselect_b32 s66, 0, s66
    s_waitcnt vmcnt(7)
    s_barrier
    s_waitcnt lgkmcnt(1)
    v_mfma_f32_32x32x16_bf16 v[48:63], a[48:51], v[16:19], v[48:63]
    ds_read_b128 v[32:35], v5 offset:20480
    ds_read_b128 v[36:39], v5 offset:22528
    ds_read_b128 v[40:43], v6 offset:20480
    ds_read_b128 v[44:47], v6 offset:22528
    v_mfma_f32_32x32x16_bf16 v[64:79], a[48:51], v[20:23], v[64:79]
    s_waitcnt lgkmcnt(4)
    v_lshl_add_u32 v8, v8, 6, v2
    s_add_u32 m0, s70, 90112
    s_nop 0
    buffer_load_dwordx4 v8, s[12:15], 0 offen lds
    v_mfma_f32_32x32x16_bf16 v[48:63], a[52:55], v[24:27], v[48:63]
    v_mfma_f32_32x32x16_bf16 v[64:79], a[52:55], v[28:31], v[64:79]
    s_waitcnt lgkmcnt(0)
    v_mfma_f32_32x32x16_bf16 v[48:63], a[56:59], v[32:35], v[48:63]
    ds_read_b128 v[16:19], v5 offset:24576
    ds_read_b128 v[20:23], v5 offset:26624
    ds_read_b128 v[24:27], v6 offset:24576
    ds_read_b128 v[28:31], v6 offset:26624
    v_mfma_f32_32x32x16_bf16 v[64:79], a[56:59], v[36:39], v[64:79]
    v_lshl_add_u32 v9, v9, 6, v2
    s_add_u32 m0, s70, 94208
    s_nop 0
    buffer_load_dwordx4 v9, s[12:15], 0 offen lds
    v_mfma_f32_32x32x16_bf16 v[48:63], a[60:63], v[40:43], v[48:63]
    v_mfma_f32_32x32x16_bf16 v[64:79], a[60:63], v[44:47], v[64:79]
    v_add_u32 v13, s66, v4
    ds_read_b64 v[8:9], v13 offset:0
    s_add_u32 s66, s66, 8
    s_cmp_ge_u32 s66, 200
    s_cselect_b32 s66, 0, s66
    s_waitcnt vmcnt(7)
    s_barrier
    s_waitcnt lgkmcnt(1)
    v_mfma_f32_32x32x16_bf16 v[48:63], a[64:67], v[16:19], v[48:63]
    ds_read_b128 v[32:35], v5 offset:28672
    ds_read_b128 v[36:39], v5 offset:30720
    ds_read_b128 v[40:43], v6 offset:28672
    ds_read_b128 v[44:47], v6 offset:30720
    v_mfma_f32_32x32x16_bf16 v[64:79], a[64:67], v[20:23], v[64:79]
    s_waitcnt lgkmcnt(4)
    v_lshl_add_u32 v8, v8, 6, v2
    s_add_u32 m0, s70, 98304
    s_nop 0
    buffer_load_dwordx4 v8, s[12:15], 0 offen lds
    v_mfma_f32_32x32x16_bf16 v[48:63], a[68:71], v[24:27], v[48:63]
    v_mfma_f32_32x32x16_bf16 v[64:79], a[68:71], v[28:31], v[64:79]
    s_waitcnt lgkmcnt(0)
    v_mfma_f32_32x32x16_bf16 v[48:63], a[72:75], v[32:35], v[48:63]
    ds_read_b128 v[16:19], v5 offset:32768
    ds_read_b128 v[20:23], v5 offset:34816
    ds_read_b128 v[24:27], v6 offset:32768
    ds_read_b128 v[28:31], v6 offset:34816
    v_mfma_f32_32x32x16_bf16 v[64:79], a[72:75], v[36:39], v[64:79]
    v_lshl_add_u32 v9, v9, 6, v2
    s_add_u32 m0, s70, 102400
    s_nop 0
    buffer_load_dwordx4 v9, s[12:15], 0 offen lds
    v_mfma_f32_32x32x16_bf16 v[48:63], a[76:79], v[40:43], v[48:63]
    v_mfma_f32_32x32x16_bf16 v[64:79], a[76:79], v[44:47], v[64:79]
    v_add_u32 v13, s66, v4
    ds_read_b64 v[8:9], v13 offset:0
    s_add_u32 s66, s66, 8
    s_cmp_ge_u32 s66, 200
    s_cselect_b32 s66, 0, s66
    s_waitcnt vmcnt(7)
    s_barrier
    s_waitcnt lgkmcnt(1)
    v_mfma_f32_32x32x16_bf16 v[48:63], a[80:83], v[16:19], v[48:63]
    ds_read_b128 v[32:35], v5 offset:36864
    ds_read_b128 v[36:39], v5 offset:38912
    ds_read_b128 v[40:43], v6 offset:36864
    ds_read_b128 v[44:47], v6 offset:38912
    v_mfma_f32_32x32x16_bf16 v[64:79], a[80:83], v[20:23], v[64:79]
    s_waitcnt lgkmcnt(4)
    v_lshl_add_u32 v8, v8, 6, v2
    s_add_u32 m0, s70, 106496
    s_nop 0
    buffer_load_dwordx4 v8, s[12:15], 0 offen lds
    v_mfma_f32_32x32x16_bf16 v[48:63], a[84:87], v[24:27], v[48:63]
    v_mfma_f32_32x32x16_bf16 v[64:79], a[84:87], v[28:31], v[64:79]
    s_waitcnt lgkmcnt(0)
    v_mfma_f32_32x32x16_bf16 v[48:63], a[88:91], v[32:35], v[48:63]
    ds_read_b128 v[16:19], v5 offset:40960
    ds_read_b128 v[20:23], v5 offset:43008
    ds_read_b128 v[24:27], v6 offset:40960
    ds_read_b128 v[28:31], v6 offset:43008
    v_mfma_f32_32x32x16_bf16 v[64:79], a[88:91], v[36:39], v[64:79]
    v_lshl_add_u32 v9, v9, 6, v2
    s_add_u32 m0, s70, 110592
    s_nop 0
    buffer_load_dwordx4 v9, s[12:15], 0 offen lds
    v_mfma_f32_32x32x16_bf16 v[48:63], a[92:95], v[40:43], v[48:63]
    v_mfma_f32_32x32x16_bf16 v[64:79], a[92:95], v[44:47], v[64:79]
    v_add_u32 v13, s66, v4
    ds_read_b64 v[8:9], v13 offset:0
    s_add_u32 s66, s66, 8
    s_cmp_ge_u32 s66, 200
    s_cselect_b32 s66, 0, s66
    s_waitcnt vmcnt(7)
    s_barrier
    s_waitcnt lgkmcnt(1)
    v_mfma_f32_32x32x16_bf16 v[48:63], a[96:99], v[16:19], v[48:63]
    ds_read_b128 v[32:35], v5 offset:45056
    ds_read_b128 v[36:39], v5 offset:47104
    ds_read_b128 v[40:43], v6 offset:45056
    ds_read_b128 v[44:47], v6 offset:47104
    v_mfma_f32_32x32x16_bf16 v[64:79], a[96:99], v[20:23], v[64:79]
    s_waitcnt lgkmcnt(4)
    v_lshl_add_u32 v8, v8, 6, v2
    s_add_u32 m0, s70, 114688
    s_nop 0
    buffer_load_dwordx4 v8, s[12:15], 0 offen lds
    v_mfma_f32_32x32x16_bf16 v[48:63], a[100:103], v[24:27], v[48:63]
    v_mfma_f32_32x32x16_bf16 v[64:79], a[100:103], v[28:31], v[64:79]
    s_waitcnt lgkmcnt(0)
    v_mfma_f32_32x32x16_bf16 v[48:63], a[104:107], v[32:35], v[48:63]
    ds_read_b128 v[16:19], v5 offset:0
    ds_read_b128 v[20:23], v5 offset:2048
    ds_read_b128 v[24:27], v6 offset:0
    ds_read_b128 v[28:31], v6 offset:2048
    v_mfma_f32_32x32x16_bf16 v[64:79], a[104:107], v[36:39], v[64:79]
    v_lshl_add_u32 v9, v9, 6, v2
    s_add_u32 m0, s70, 118784
    s_nop 0
    buffer_load_dwordx4 v9, s[12:15], 0 offen lds
    v_mfma_f32_32x32x16_bf16 v[48:63], a[108:111], v[40:43], v[48:63]
    v_mfma_f32_32x32x16_bf16 v[64:79], a[108:111], v[44:47], v[64:79]
    v_add_u32 v13, s66, v4
    ds_read_b64 v[8:9], v13 offset:0
    s_add_u32 s66, s66, 8
    s_cmp_ge_u32 s66, 200
    s_cselect_b32 s66, 0, s66
    s_waitcnt vmcnt(7)
    s_barrier
    s_waitcnt lgkmcnt(1)
    v_mfma_f32_32x32x16_bf16 v[48:63], a[112:115], v[16:19], v[48:63]
    ds_read_b128 v[32:35], v5 offset:4096
    ds_read_b128 v[36:39], v5 offset:6144
    ds_read_b128 v[40:43], v6 offset:4096
    ds_read_b128 v[44:47], v6 offset:6144
    v_mfma_f32_32x32x16_bf16 v[64:79], a[112:115], v[20:23], v[64:79]
    s_waitcnt lgkmcnt(4)
    v_lshl_add_u32 v8, v8, 6, v2
    s_add_u32 m0, s70, 122880
    s_nop 0
    buffer_load_dwordx4 v8, s[12:15], 0 offen lds
    v_mfma_f32_32x32x16_bf16 v[48:63], a[116:119], v[24:27], v[48:63]
    v_mfma_f32_32x32x16_bf16 v[64:79], a[116:119], v[28:31], v[64:79]
    s_waitcnt lgkmcnt(0)
    v_mfma_f32_32x32x16_bf16 v[48:63], a[120:123], v[32:35], v[48:63]
    ds_read_b128 v[16:19], v5 offset:8192
    ds_read_b128 v[20:23], v5 offset:10240
    ds_read_b128 v[24:27], v6 offset:8192
    ds_read_b128 v[28:31], v6 offset:10240
    v_mfma_f32_32x32x16_bf16 v[64:79], a[120:123], v[36:39], v[64:79]
    v_lshl_add_u32 v9, v9, 6, v2
    s_add_u32 m0, s70, 126976
    s_nop 0
    buffer_load_dwordx4 v9, s[12:15], 0 offen lds
    v_mfma_f32_32x32x16_bf16 v[48:63], a[124:127], v[40:43], v[48:63]
    v_mfma_f32_32x32x16_bf16 v[64:79], a[124:127], v[44:47], v[64:79]
    v_add_u32 v13, s66, v4
    ds_read_b64 v[8:9], v13 offset:0
    s_add_u32 s66, s66, 8
    s_cmp_ge_u32 s66, 200
    s_cselect_b32 s66, 0, s66
    s_waitcnt vmcnt(7)
    s_barrier
    s_waitcnt lgkmcnt(1)
    v_mfma_f32_32x32x16_bf16 v[48:63], a[128:131], v[16:19], v[48:63]
    ds_read_b128 v[32:35], v5 offset:12288
    ds_read_b128 v[36:39], v5 offset:14336
    ds_read_b128 v[40:43], v6 offset:12288
    ds_read_b128 v[44:47], v6 offset:14336
    v_mfma_f32_32x32x16_bf16 v[64:79], a[128:131], v[20:23], v[64:79]
    s_waitcnt lgkmcnt(4)
    v_lshl_add_u32 v8, v8, 6, v2
    s_add_u32 m0, s70, 81920
    s_nop 0
    buffer_load_dwordx4 v8, s[12:15], 0 offen lds
    v_mfma_f32_32x32x16_bf16 v[48:63], a[132:135], v[24:27], v[48:63]
    v_mfma_f32_32x32x16_bf16 v[64:79], a[132:135], v[28:31], v[64:79]
    s_waitcnt lgkmcnt(0)
    v_mfma_f32_32x32x16_bf16 v[48:63], a[136:139], v[32:35], v[48:63]
    ds_read_b128 v[16:19], v5 offset:16384
    ds_read_b128 v[20:23], v5 offset:18432
    ds_read_b128 v[24:27], v6 offset:16384
    ds_read_b128 v[28:31], v6 offset:18432
    v_mfma_f32_32x32x16_bf16 v[64:79], a[136:139], v[36:39], v[64:79]
    v_lshl_add_u32 v9, v9, 6, v2
    s_add_u32 m0, s70, 86016
    s_nop 0
    buffer_load_dwordx4 v9, s[12:15], 0 offen lds
    v_mfma_f32_32x32x16_bf16 v[48:63], a[140:143], v[40:43], v[48:63]
    v_mfma_f32_32x32x16_bf16 v[64:79], a[140:143], v[44:47], v[64:79]
    v_add_u32 v13, s66, v4
    ds_read_b64 v[8:9], v13 offset:0
    s_add_u32 s66, s66, 8
    s_cmp_ge_u32 s66, 200
    s_cselect_b32 s66, 0, s66
    s_waitcnt vmcnt(7)
    s_barrier
    s_waitcnt lgkmcnt(1)
    v_mfma_f32_32x32x16_bf16 v[48:63], a[144:147], v[16:19], v[48:63]
    ds_read_b128 v[32:35], v5 offset:20480
    ds_read_b128 v[36:39], v5 offset:22528
    ds_read_b128 v[40:43], v6 offset:20480
    ds_read_b128 v[44:47], v6 offset:22528
    v_mfma_f32_32x32x16_bf16 v[64:79], a[144:147], v[20:23], v[64:79]
    s_waitcnt lgkmcnt(4)
    v_lshl_add_u32 v8, v8, 6, v2
    s_add_u32 m0, s70, 90112
    s_nop 0
    buffer_load_dwordx4 v8, s[12:15], 0 offen lds
    v_mfma_f32_32x32x16_bf16 v[48:63], a[148:151], v[24:27], v[48:63]
    v_mfma_f32_32x32x16_bf16 v[64:79], a[148:151], v[28:31], v[64:79]
    s_waitcnt lgkmcnt(0)
    v_mfma_f32_32x32x16_bf16 v[48:63], a[152:155], v[32:35], v[48:63]
    ds_read_b128 v[16:19], v5 offset:24576
    ds_read_b128 v[20:23], v5 offset:26624
    ds_read_b128 v[24:27], v6 offset:24576
    ds_read_b128 v[28:31], v6 offset:26624
    v_mfma_f32_32x32x16_bf16 v[64:79], a[152:155], v[36:39], v[64:79]
    v_lshl_add_u32 v9, v9, 6, v2
    s_add_u32 m0, s70, 94208
    s_nop 0
    buffer_load_dwordx4 v9, s[12:15], 0 offen lds
    v_mfma_f32_32x32x16_bf16 v[48:63], a[156:159], v[40:43], v[48:63]
    v_mfma_f32_32x32x16_bf16 v[64:79], a[156:159], v[44:47], v[64:79]
    v_add_u32 v13, s66, v4
    ds_read_b64 v[8:9], v13 offset:0
    s_add_u32 s66, s66, 8
    s_cmp_ge_u32 s66, 200
    s_cselect_b32 s66, 0, s66
    s_waitcnt vmcnt(7)
    s_barrier
    s_waitcnt lgkmcnt(1)
    v_mfma_f32_32x32x16_bf16 v[48:63], a[160:163], v[16:19], v[48:63]
    ds_read_b128 v[32:35], v5 offset:28672
    ds_read_b128 v[36:39], v5 offset:30720
    ds_read_b128 v[40:43], v6 offset:28672
    ds_read_b128 v[44:47], v6 offset:30720
    v_mfma_f32_32x32x16_bf16 v[64:79], a[160:163], v[20:23], v[64:79]
    s_waitcnt lgkmcnt(4)
    v_lshl_add_u32 v8, v8, 6, v2
    s_add_u32 m0, s70, 98304
    s_nop 0
    buffer_load_dwordx4 v8, s[12:15], 0 offen lds
    v_mfma_f32_32x32x16_bf16 v[48:63], a[164:167], v[24:27], v[48:63]
    v_mfma_f32_32x32x16_bf16 v[64:79], a[164:167], v[28:31], v[64:79]
    v_add_u32 v13, s67, v4
    ds_read_b64 v[10:11], v13 offset:13312
    s_add_u32 s67, s67, 8
    s_cmp_ge_u32 s67, 200
    s_cselect_b32 s67, 0, s67
    s_waitcnt lgkmcnt(1)
    v_mfma_f32_32x32x16_bf16 v[48:63], a[168:171], v[32:35], v[48:63]
    ds_read_b128 v[16:19], v5 offset:32768
    ds_read_b128 v[20:23], v5 offset:34816
    ds_read_b128 v[24:27], v6 offset:32768
    ds_read_b128 v[28:31], v6 offset:34816
    v_mfma_f32_32x32x16_bf16 v[64:79], a[168:171], v[36:39], v[64:79]
    v_lshl_add_u32 v9, v9, 6, v2
    s_add_u32 m0, s70, 102400
    s_nop 0
    buffer_load_dwordx4 v9, s[12:15], 0 offen lds
    v_mfma_f32_32x32x16_bf16 v[48:63], a[172:175], v[40:43], v[48:63]
    v_mfma_f32_32x32x16_bf16 v[64:79], a[172:175], v[44:47], v[64:79]
    s_waitcnt vmcnt(7)
    s_barrier
    s_waitcnt lgkmcnt(0)
    v_mfma_f32_32x32x16_bf16 v[48:63], a[176:179], v[16:19], v[48:63]
    ds_read_b128 v[32:35], v5 offset:36864
    ds_read_b128 v[36:39], v5 offset:38912
    ds_read_b128 v[40:43], v6 offset:36864
    ds_read_b128 v[44:47], v6 offset:38912
    v_mfma_f32_32x32x16_bf16 v[64:79], a[176:179], v[20:23], v[64:79]
    v_lshl_add_u32 v10, v10, 6, v2
    s_add_u32 m0, s70, 106496
    s_nop 0
    buffer_load_dwordx4 v10, s[12:15], 0 offen lds
    v_mfma_f32_32x32x16_bf16 v[48:63], a[180:183], v[24:27], v[48:63]
    v_mfma_f32_32x32x16_bf16 v[64:79], a[180:183], v[28:31], v[64:79]
    s_waitcnt lgkmcnt(0)
    v_mfma_f32_32x32x16_bf16 v[48:63], a[184:187], v[32:35], v[48:63]
    ds_read_b128 v[16:19], v5 offset:40960
    ds_read_b128 v[20:23], v5 offset:43008
    ds_read_b128 v[24:27], v6 offset:40960
    ds_read_b128 v[28:31], v6 offset:43008
    v_mfma_f32_32x32x16_bf16 v[64:79], a[184:187], v[36:39], v[64:79]
    v_lshl_add_u32 v11, v11, 6, v2
    s_add_u32 m0, s70, 110592
    s_nop 0
    buffer_load_dwordx4 v11, s[12:15], 0 offen lds
    v_mfma_f32_32x32x16_bf16 v[48:63], a[188:191], v[40:43], v[48:63]
    v_mfma_f32_32x32x16_bf16 v[64:79], a[188:191], v[44:47], v[64:79]
    v_add_u32 v13, s67, v4
    ds_read_b64 v[10:11], v13 offset:13312
    s_add_u32 s67, s67, 8
    s_cmp_ge_u32 s67, 200
    s_cselect_b32 s67, 0, s67
    s_waitcnt vmcnt(7)
    s_barrier
    s_waitcnt lgkmcnt(1)
    v_mfma_f32_32x32x16_bf16 v[48:63], a[192:195], v[16:19], v[48:63]
    ds_read_b128 v[32:35], v5 offset:45056
    ds_read_b128 v[36:39], v5 offset:47104
    ds_read_b128 v[40:43], v6 offset:45056
    ds_read_b128 v[44:47], v6 offset:47104
    v_mfma_f32_32x32x16_bf16 v[64:79], a[192:195], v[20:23], v[64:79]
    s_waitcnt lgkmcnt(4)
    v_lshl_add_u32 v10, v10, 6, v2
    s_add_u32 m0, s70, 114688
    s_nop 0
    buffer_load_dwordx4 v10, s[12:15], 0 offen lds
    v_mfma_f32_32x32x16_bf16 v[48:63], a[196:199], v[24:27], v[48:63]
    v_mfma_f32_32x32x16_bf16 v[64:79], a[196:199], v[28:31], v[64:79]
    s_waitcnt lgkmcnt(0)
    v_mfma_f32_32x32x16_bf16 v[48:63], a[200:203], v[32:35], v[48:63]
    ds_read_b128 v[16:19], v5 offset:0
    ds_read_b128 v[20:23], v5 offset:2048
    ds_read_b128 v[24:27], v6 offset:0
    ds_read_b128 v[28:31], v6 offset:2048
    v_mfma_f32_32x32x16_bf16 v[64:79], a[200:203], v[36:39], v[64:79]
    v_lshl_add_u32 v11, v11, 6, v2
    s_add_u32 m0, s70, 118784
    s_nop 0
    buffer_load_dwordx4 v11, s[12:15], 0 offen lds
    v_mfma_f32_32x32x16_bf16 v[48:63], a[204:207], v[40:43], v[48:63]
    v_mfma_f32_32x32x16_bf16 v[64:79], a[204:207], v[44:47], v[64:79]
    v_add_u32 v13, s67, v4
    ds_read_b64 v[10:11], v13 offset:13312
    s_add_u32 s67, s67, 8
    s_cmp_ge_u32 s67, 200
    s_cselect_b32 s67, 0, s67
    s_waitcnt vmcnt(7)
    s_barrier
    s_waitcnt lgkmcnt(1)
    v_mfma_f32_32x32x16_bf16 v[48:63], a[208:211], v[16:19], v[48:63]
    ds_read_b128 v[32:35], v5 offset:4096
    ds_read_b128 v[36:39], v5 offset:6144
    ds_read_b128 v[40:43], v6 offset:4096
    ds_read_b128 v[44:47], v6 offset:6144
    v_mfma_f32_32x32x16_bf16 v[64:79], a[208:211], v[20:23], v[64:79]
    s_waitcnt lgkmcnt(4)
    v_lshl_add_u32 v10, v10, 6, v2
    s_add_u32 m0, s70, 122880
    s_nop 0
    buffer_load_dwordx4 v10, s[12:15], 0 offen lds
    v_mfma_f32_32x32x16_bf16 v[48:63], a[212:215], v[24:27], v[48:63]
    v_mfma_f32_32x32x16_bf16 v[64:79], a[212:215], v[28:31], v[64:79]
    s_waitcnt lgkmcnt(0)
    v_mfma_f32_32x32x16_bf16 v[48:63], a[216:219], v[32:35], v[48:63]
    ds_read_b128 v[16:19], v5 offset:8192
    ds_read_b128 v[20:23], v5 offset:10240
    ds_read_b128 v[24:27], v6 offset:8192
    ds_read_b128 v[28:31], v6 offset:10240
    v_mfma_f32_32x32x16_bf16 v[64:79], a[216:219], v[36:39], v[64:79]
    v_lshl_add_u32 v11, v11, 6, v2
    s_add_u32 m0, s70, 126976
    s_nop 0
    buffer_load_dwordx4 v11, s[12:15], 0 offen lds
    v_mfma_f32_32x32x16_bf16 v[48:63], a[220:223], v[40:43], v[48:63]
    v_mfma_f32_32x32x16_bf16 v[64:79], a[220:223], v[44:47], v[64:79]
    v_add_u32 v13, s67, v4
    ds_read_b64 v[10:11], v13 offset:13312
    s_add_u32 s67, s67, 8
    s_cmp_ge_u32 s67, 200
    s_cselect_b32 s67, 0, s67
    s_waitcnt vmcnt(7)
    s_barrier
    s_waitcnt lgkmcnt(1)
    v_mfma_f32_32x32x16_bf16 v[48:63], a[224:227], v[16:19], v[48:63]
    ds_read_b128 v[32:35], v5 offset:12288
    ds_read_b128 v[36:39], v5 offset:14336
    ds_read_b128 v[40:43], v6 offset:12288
    ds_read_b128 v[44:47], v6 offset:14336
    v_mfma_f32_32x32x16_bf16 v[64:79], a[224:227], v[20:23], v[64:79]
    s_waitcnt lgkmcnt(4)
    v_lshl_add_u32 v10, v10, 6, v2
    s_add_u32 m0, s70, 81920
    s_nop 0
    buffer_load_dwordx4 v10, s[12:15], 0 offen lds
    v_mfma_f32_32x32x16_bf16 v[48:63], a[228:231], v[24:27], v[48:63]
    v_mfma_f32_32x32x16_bf16 v[64:79], a[228:231], v[28:31], v[64:79]
    s_waitcnt lgkmcnt(0)
    v_mfma_f32_32x32x16_bf16 v[48:63], a[232:235], v[32:35], v[48:63]
    ds_read_b128 v[16:19], v5 offset:16384
    ds_read_b128 v[20:23], v5 offset:18432
    ds_read_b128 v[24:27], v6 offset:16384
    ds_read_b128 v[28:31], v6 offset:18432
    v_mfma_f32_32x32x16_bf16 v[64:79], a[232:235], v[36:39], v[64:79]
    v_lshl_add_u32 v11, v11, 6, v2
    s_add_u32 m0, s70, 86016
    s_nop 0
    buffer_load_dwordx4 v11, s[12:15], 0 offen lds
    v_mfma_f32_32x32x16_bf16 v[48:63], a[236:239], v[40:43], v[48:63]
    v_mfma_f32_32x32x16_bf16 v[64:79], a[236:239], v[44:47], v[64:79]
    v_add_u32 v13, s67, v4
    ds_read_b64 v[10:11], v13 offset:13312
    s_add_u32 s67, s67, 8
    s_cmp_ge_u32 s67, 200
    s_cselect_b32 s67, 0, s67
    s_waitcnt vmcnt(7)
    s_barrier
    s_waitcnt lgkmcnt(1)
    v_mfma_f32_32x32x16_bf16 v[48:63], a[240:243], v[16:19], v[48:63]
    ds_read_b128 v[32:35], v5 offset:20480
    ds_read_b128 v[36:39], v5 offset:22528
    ds_read_b128 v[40:43], v6 offset:20480
    ds_read_b128 v[44:47], v6 offset:22528
    v_mfma_f32_32x32x16_bf16 v[64:79], a[240:243], v[20:23], v[64:79]
    s_waitcnt lgkmcnt(4)
    v_lshl_add_u32 v10, v10, 6, v2
    s_add_u32 m0, s70, 90112
    s_nop 0
    buffer_load_dwordx4 v10, s[12:15], 0 offen lds
    v_mfma_f32_32x32x16_bf16 v[48:63], a[244:247], v[24:27], v[48:63]
    v_mfma_f32_32x32x16_bf16 v[64:79], a[244:247], v[28:31], v[64:79]
    s_waitcnt lgkmcnt(0)
    v_mfma_f32_32x32x16_bf16 v[48:63], a[248:251], v[32:35], v[48:63]
    ds_read_b128 v[16:19], v5 offset:24576
    ds_read_b128 v[20:23], v5 offset:26624
    ds_read_b128 v[24:27], v6 offset:24576
    ds_read_b128 v[28:31], v6 offset:26624
    v_mfma_f32_32x32x16_bf16 v[64:79], a[248:251], v[36:39], v[64:79]
    v_lshl_add_u32 v11, v11, 6, v2
    s_add_u32 m0, s70, 94208
    s_nop 0
    buffer_load_dwordx4 v11, s[12:15], 0 offen lds
    v_mfma_f32_32x32x16_bf16 v[48:63], a[252:255], v[40:43], v[48:63]
    v_mfma_f32_32x32x16_bf16 v[64:79], a[252:255], v[44:47], v[64:79]
    v_add_u32 v13, s67, v4
    ds_read_b64 v[10:11], v13 offset:13312
    s_add_u32 s67, s67, 8
    s_cmp_ge_u32 s67, 200
    s_cselect_b32 s67, 0, s67
    s_nop 15
    v_lshlrev_b32 v12, 4, v1
    v_cvt_pk_bf16_f32 v48, v48, v49
    v_cvt_pk_bf16_f32 v49, v50, v51
    v_cvt_pk_bf16_f32 v50, v52, v53
    v_cvt_pk_bf16_f32 v51, v54, v55
    v_cvt_pk_bf16_f32 v52, v56, v57
    v_cvt_pk_bf16_f32 v53, v58, v59
    v_cvt_pk_bf16_f32 v54, v60, v61
    v_cvt_pk_bf16_f32 v55, v62, v63
    v_cvt_pk_bf16_f32 v56, v64, v65
    v_cvt_pk_bf16_f32 v57, v66, v67
    v_cvt_pk_bf16_f32 v58, v68, v69
    v_cvt_pk_bf16_f32 v59, v70, v71
    v_cvt_pk_bf16_f32 v60, v72, v73
    v_cvt_pk_bf16_f32 v61, v74, v75
    v_cvt_pk_bf16_f32 v62, v76, v77
    v_cvt_pk_bf16_f32 v63, v78, v79
    v_lshlrev_b32 v12, 4, v1
    buffer_store_dwordx4 v[48:51], v12, s[32:35], s77 offen offset:0 sc1
    s_waitcnt vmcnt(8)
    s_barrier
    s_waitcnt lgkmcnt(1)
    v_mfma_f32_32x32x16_bf16 v[80:95], v[112:115], v[16:19], v[80:95]
    ds_read_b128 v[32:35], v5 offset:28672
    ds_read_b128 v[36:39], v5 offset:30720
    ds_read_b128 v[40:43], v6 offset:28672
    ds_read_b128 v[44:47], v6 offset:30720
    v_mfma_f32_32x32x16_bf16 v[96:111], v[112:115], v[20:23], v[96:111]
    s_waitcnt lgkmcnt(4)
    v_lshl_add_u32 v10, v10, 6, v2
    s_add_u32 m0, s70, 98304
    s_nop 0
    buffer_load_dwordx4 v10, s[12:15], 0 offen lds
    v_mfma_f32_32x32x16_bf16 v[80:95], v[116:119], v[24:27], v[80:95]
    v_mfma_f32_32x32x16_bf16 v[96:111], v[116:119], v[28:31], v[96:111]
    s_waitcnt lgkmcnt(0)
    v_mfma_f32_32x32x16_bf16 v[80:95], v[120:123], v[32:35], v[80:95]
    ds_read_b128 v[16:19], v5 offset:32768
    ds_read_b128 v[20:23], v5 offset:34816
    ds_read_b128 v[24:27], v6 offset:32768
    ds_read_b128 v[28:31], v6 offset:34816
    v_mfma_f32_32x32x16_bf16 v[96:111], v[120:123], v[36:39], v[96:111]
    v_lshl_add_u32 v11, v11, 6, v2
    s_add_u32 m0, s70, 102400
    s_nop 0
    buffer_load_dwordx4 v11, s[12:15], 0 offen lds
    v_mfma_f32_32x32x16_bf16 v[80:95], v[124:127], v[40:43], v[80:95]
    v_mfma_f32_32x32x16_bf16 v[96:111], v[124:127], v[44:47], v[96:111]
    v_add_u32 v13, s67, v4
    ds_read_b64 v[10:11], v13 offset:13312
    s_add_u32 s67, s67, 8
    s_cmp_ge_u32 s67, 200
    s_cselect_b32 s67, 0, s67
    s_waitcnt vmcnt(8)
    s_barrier
    s_waitcnt lgkmcnt(1)
    v_mfma_f32_32x32x16_bf16 v[80:95], v[128:131], v[16:19], v[80:95]
    ds_read_b128 v[32:35], v5 offset:36864
    ds_read_b128 v[36:39], v5 offset:38912
    ds_read_b128 v[40:43], v6 offset:36864
    ds_read_b128 v[44:47], v6 offset:38912
    v_mfma_f32_32x32x16_bf16 v[96:111], v[128:131], v[20:23], v[96:111]
    s_waitcnt lgkmcnt(4)
    v_lshl_add_u32 v10, v10, 6, v2
    s_add_u32 m0, s70, 106496
    s_nop 0
    buffer_load_dwordx4 v10, s[12:15], 0 offen lds
    v_mfma_f32_32x32x16_bf16 v[80:95], v[132:135], v[24:27], v[80:95]
    v_mfma_f32_32x32x16_bf16 v[96:111], v[132:135], v[28:31], v[96:111]
    v_mov_b32 v14, s3
    buffer_load_dword v15, v14, s[32:35], 0 offen offset:128 sc1
    s_waitcnt lgkmcnt(0)
    v_mfma_f32_32x32x16_bf16 v[80:95], v[136:139], v[32:35], v[80:95]
    ds_read_b128 v[16:19], v5 offset:40960
    ds_read_b128 v[20:23], v5 offset:43008
    ds_read_b128 v[24:27], v6 offset:40960
    ds_read_b128 v[28:31], v6 offset:43008
    v_mfma_f32_32x32x16_bf16 v[96:111], v[136:139], v[36:39], v[96:111]
    v_lshl_add_u32 v11, v11, 6, v2
    s_add_u32 m0, s70, 110592
    s_nop 0
    buffer_load_dwordx4 v11, s[12:15], 0 offen lds
    v_mfma_f32_32x32x16_bf16 v[80:95], v[140:143], v[40:43], v[80:95]
    v_mfma_f32_32x32x16_bf16 v[96:111], v[140:143], v[44:47], v[96:111]
    v_add_u32 v13, s67, v4
    ds_read_b64 v[10:11], v13 offset:13312
    s_add_u32 s67, s67, 8
    s_cmp_ge_u32 s67, 200
    s_cselect_b32 s67, 0, s67
    v_lshlrev_b32 v12, 4, v1
    buffer_store_dwordx4 v[52:55], v12, s[32:35], s77 offen offset:1024 sc1
    s_waitcnt vmcnt(10)
    s_barrier
    s_waitcnt lgkmcnt(1)
    v_mfma_f32_32x32x16_bf16 v[80:95], v[144:147], v[16:19], v[80:95]
    ds_read_b128 v[32:35], v5 offset:45056
    ds_read_b128 v[36:39], v5 offset:47104
    ds_read_b128 v[40:43], v6 offset:45056
    ds_read_b128 v[44:47], v6 offset:47104
    v_mfma_f32_32x32x16_bf16 v[96:111], v[144:147], v[20:23], v[96:111]
    s_waitcnt lgkmcnt(4)
    v_lshl_add_u32 v10, v10, 6, v2
    s_add_u32 m0, s70, 114688
    s_nop 0
    buffer_load_dwordx4 v10, s[12:15], 0 offen lds
    v_mfma_f32_32x32x16_bf16 v[80:95], v[148:151], v[24:27], v[80:95]
    v_mfma_f32_32x32x16_bf16 v[96:111], v[148:151], v[28:31], v[96:111]
    s_waitcnt lgkmcnt(0)
    v_mfma_f32_32x32x16_bf16 v[80:95], v[152:155], v[32:35], v[80:95]
    ds_read_b128 v[16:19], v5 offset:0
    ds_read_b128 v[20:23], v5 offset:2048
    ds_read_b128 v[24:27], v6 offset:0
    ds_read_b128 v[28:31], v6 offset:2048
    v_mfma_f32_32x32x16_bf16 v[96:111], v[152:155], v[36:39], v[96:111]
    v_lshl_add_u32 v11, v11, 6, v2
    s_add_u32 m0, s70, 118784
    s_nop 0
    buffer_load_dwordx4 v11, s[12:15], 0 offen lds
    v_mfma_f32_32x32x16_bf16 v[80:95], v[156:159], v[40:43], v[80:95]
    v_mfma_f32_32x32x16_bf16 v[96:111], v[156:159], v[44:47], v[96:111]
    v_add_u32 v13, s67, v4
    ds_read_b64 v[10:11], v13 offset:13312
    s_add_u32 s67, s67, 8
    s_cmp_ge_u32 s67, 200
    s_cselect_b32 s67, 0, s67
    s_waitcnt vmcnt(10)
    s_barrier
    s_waitcnt lgkmcnt(1)
    v_mfma_f32_32x32x16_bf16 v[80:95], v[160:163], v[16:19], v[80:95]
    ds_read_b128 v[32:35], v5 offset:4096
    ds_read_b128 v[36:39], v5 offset:6144
    ds_read_b128 v[40:43], v6 offset:4096
    ds_read_b128 v[44:47], v6 offset:6144
    v_mfma_f32_32x32x16_bf16 v[96:111], v[160:163], v[20:23], v[96:111]
    s_waitcnt lgkmcnt(4)
    v_lshl_add_u32 v10, v10, 6, v2
    s_add_u32 m0, s70, 122880
    s_nop 0
    buffer_load_dwordx4 v10, s[12:15], 0 offen lds
    v_mfma_f32_32x32x16_bf16 v[80:95], v[164:167], v[24:27], v[80:95]
    v_mfma_f32_32x32x16_bf16 v[96:111], v[164:167], v[28:31], v[96:111]
    s_waitcnt lgkmcnt(0)
    v_mfma_f32_32x32x16_bf16 v[80:95], v[168:171], v[32:35], v[80:95]
    ds_read_b128 v[16:19], v5 offset:8192
    ds_read_b128 v[20:23], v5 offset:10240
    ds_read_b128 v[24:27], v6 offset:8192
    ds_read_b128 v[28:31], v6 offset:10240
    v_mfma_f32_32x32x16_bf16 v[96:111], v[168:171], v[36:39], v[96:111]
    v_lshl_add_u32 v11, v11, 6, v2
    s_add_u32 m0, s70, 126976
    s_nop 0
    buffer_load_dwordx4 v11, s[12:15], 0 offen lds
    v_mfma_f32_32x32x16_bf16 v[80:95], v[172:175], v[40:43], v[80:95]
    v_mfma_f32_32x32x16_bf16 v[96:111], v[172:175], v[44:47], v[96:111]
    v_add_u32 v13, s67, v4
    ds_read_b64 v[10:11], v13 offset:13312
    s_add_u32 s67, s67, 8
    s_cmp_ge_u32 s67, 200
    s_cselect_b32 s67, 0, s67
    v_lshlrev_b32 v12, 4, v1
    buffer_store_dwordx4 v[56:59], v12, s[32:35], s77 offen offset:2048 sc1
    s_waitcnt vmcnt(10)
    s_barrier
    s_waitcnt lgkmcnt(1)
    v_mfma_f32_32x32x16_bf16 v[80:95], v[176:179], v[16:19], v[80:95]
    ds_read_b128 v[32:35], v5 offset:12288
    ds_read_b128 v[36:39], v5 offset:14336
    ds_read_b128 v[40:43], v6 offset:12288
    ds_read_b128 v[44:47], v6 offset:14336
    v_mfma_f32_32x32x16_bf16 v[96:111], v[176:179], v[20:23], v[96:111]
    s_waitcnt lgkmcnt(4)
    v_lshl_add_u32 v10, v10, 6, v2
    s_add_u32 m0, s70, 81920
    s_nop 0
    buffer_load_dwordx4 v10, s[12:15], 0 offen lds
    v_mfma_f32_32x32x16_bf16 v[80:95], v[180:183], v[24:27], v[80:95]
    v_mfma_f32_32x32x16_bf16 v[96:111], v[180:183], v[28:31], v[96:111]
    s_waitcnt lgkmcnt(0)
    v_mfma_f32_32x32x16_bf16 v[80:95], v[184:187], v[32:35], v[80:95]
    ds_read_b128 v[16:19], v5 offset:16384
    ds_read_b128 v[20:23], v5 offset:18432
    ds_read_b128 v[24:27], v6 offset:16384
    ds_read_b128 v[28:31], v6 offset:18432
    v_mfma_f32_32x32x16_bf16 v[96:111], v[184:187], v[36:39], v[96:111]
    v_lshl_add_u32 v11, v11, 6, v2
    s_add_u32 m0, s70, 86016
    s_nop 0
    buffer_load_dwordx4 v11, s[12:15], 0 offen lds
    v_mfma_f32_32x32x16_bf16 v[80:95], v[188:191], v[40:43], v[80:95]
    v_mfma_f32_32x32x16_bf16 v[96:111], v[188:191], v[44:47], v[96:111]
    v_add_u32 v13, s67, v4
    ds_read_b64 v[10:11], v13 offset:13312
    s_add_u32 s67, s67, 8
    s_cmp_ge_u32 s67, 200
    s_cselect_b32 s67, 0, s67
    s_waitcnt vmcnt(10)
    s_barrier
    s_waitcnt lgkmcnt(1)
    v_mfma_f32_32x32x16_bf16 v[80:95], v[192:195], v[16:19], v[80:95]
    ds_read_b128 v[32:35], v5 offset:20480
    ds_read_b128 v[36:39], v5 offset:22528
    ds_read_b128 v[40:43], v6 offset:20480
    ds_read_b128 v[44:47], v6 offset:22528
    v_mfma_f32_32x32x16_bf16 v[96:111], v[192:195], v[20:23], v[96:111]
    s_waitcnt lgkmcnt(4)
    v_lshl_add_u32 v10, v10, 6, v2
    s_add_u32 m0, s70, 90112
    s_nop 0
    buffer_load_dwordx4 v10, s[12:15], 0 offen lds
    v_mfma_f32_32x32x16_bf16 v[80:95], v[196:199], v[24:27], v[80:95]
    v_mfma_f32_32x32x16_bf16 v[96:111], v[196:199], v[28:31], v[96:111]
    s_waitcnt vmcnt(10)
    v_readfirstlane_b32 s71, v15
    s_nop 1
    s_cmp_eq_u32 s71, s79
    s_cbranch_scc0 L_rspin
L_rspin_done:
    s_waitcnt lgkmcnt(0)
    v_mfma_f32_32x32x16_bf16 v[80:95], v[200:203], v[32:35], v[80:95]
    ds_read_b128 v[16:19], v5 offset:24576
    ds_read_b128 v[20:23], v5 offset:26624
    ds_read_b128 v[24:27], v6 offset:24576
    ds_read_b128 v[28:31], v6 offset:26624
    v_mfma_f32_32x32x16_bf16 v[96:111], v[200:203], v[36:39], v[96:111]
    v_lshl_add_u32 v11, v11, 6, v2
    s_add_u32 m0, s70, 94208
    s_nop 0
    buffer_load_dwordx4 v11, s[12:15], 0 offen lds
    v_mfma_f32_32x32x16_bf16 v[80:95], v[204:207], v[40:43], v[80:95]
    v_mfma_f32_32x32x16_bf16 v[96:111], v[204:207], v[44:47], v[96:111]
    v_add_u32 v13, s67, v4
    ds_read_b64 v[10:11], v13 offset:13312
    s_add_u32 s67, s67, 8
    s_cmp_ge_u32 s67, 200
    s_cselect_b32 s67, 0, s67
    v_lshlrev_b32 v12, 4, v1
    buffer_store_dwordx4 v[60:63], v12, s[32:35], s77 offen offset:3072 sc1
    s_waitcnt vmcnt(9)
    s_barrier
    s_waitcnt lgkmcnt(1)
    v_mfma_f32_32x32x16_bf16 v[80:95], v[208:211], v[16:19], v[80:95]
    ds_read_b128 v[32:35], v5 offset:28672
    ds_read_b128 v[36:39], v5 offset:30720
    ds_read_b128 v[40:43], v6 offset:28672
    ds_read_b128 v[44:47], v6 offset:30720
    v_mfma_f32_32x32x16_bf16 v[96:111], v[208:211], v[20:23], v[96:111]
    s_waitcnt lgkmcnt(4)
    v_lshl_add_u32 v10, v10, 6, v2
    s_add_u32 m0, s70, 98304
    s_nop 0
    buffer_load_dwordx4 v10, s[12:15], 0 offen lds
    v_mfma_f32_32x32x16_bf16 v[80:95], v[212:215], v[24:27], v[80:95]
    v_mfma_f32_32x32x16_bf16 v[96:111], v[212:215], v[28:31], v[96:111]
    s_waitcnt lgkmcnt(0)
    v_mfma_f32_32x32x16_bf16 v[80:95], v[216:219], v[32:35], v[80:95]
    ds_read_b128 v[16:19], v5 offset:32768
    ds_read_b128 v[20:23], v5 offset:34816
    ds_read_b128 v[24:27], v6 offset:32768
    ds_read_b128 v[28:31], v6 offset:34816
    v_mfma_f32_32x32x16_bf16 v[96:111], v[216:219], v[36:39], v[96:111]
    v_lshl_add_u32 v11, v11, 6, v2
    s_add_u32 m0, s70, 102400
    s_nop 0
    buffer_load_dwordx4 v11, s[12:15], 0 offen lds
    v_mfma_f32_32x32x16_bf16 v[80:95], v[220:223], v[40:43], v[80:95]
    v_mfma_f32_32x32x16_bf16 v[96:111], v[220:223], v[44:47], v[96:111]
    v_add_u32 v13, s67, v4
    ds_read_b64 v[10:11], v13 offset:13312
    s_add_u32 s67, s67, 8
    s_cmp_ge_u32 s67, 200
    s_cselect_b32 s67, 0, s67
    s_waitcnt vmcnt(9)
    s_barrier
    s_waitcnt lgkmcnt(1)
    v_mfma_f32_32x32x16_bf16 v[80:95], v[224:227], v[16:19], v[80:95]
    ds_read_b128 v[32:35], v5 offset:36864
    ds_read_b128 v[36:39], v5 offset:38912
    ds_read_b128 v[40:43], v6 offset:36864
    ds_read_b128 v[44:47], v6 offset:38912
    v_mfma_f32_32x32x16_bf16 v[96:111], v[224:227], v[20:23], v[96:111]
    s_waitcnt lgkmcnt(4)
    v_lshl_add_u32 v10, v10, 6, v2
    s_add_u32 m0, s70, 106496
    s_nop 0
    buffer_load_dwordx4 v10, s[12:15], 0 offen lds
    v_mfma_f32_32x32x16_bf16 v[80:95], v[228:231], v[24:27], v[80:95]
    v_mfma_f32_32x32x16_bf16 v[96:111], v[228:231], v[28:31], v[96:111]
    s_waitcnt lgkmcnt(0)
    v_mfma_f32_32x32x16_bf16 v[80:95], v[232:235], v[32:35], v[80:95]
    ds_read_b128 v[16:19], v5 offset:40960
    ds_read_b128 v[20:23], v5 offset:43008
    ds_read_b128 v[24:27], v6 offset:40960
    ds_read_b128 v[28:31], v6 offset:43008
    v_mfma_f32_32x32x16_bf16 v[96:111], v[232:235], v[36:39], v[96:111]
    v_lshl_add_u32 v11, v11, 6, v2
    s_add_u32 m0, s70, 110592
    s_nop 0
    buffer_load_dwordx4 v11, s[12:15], 0 offen lds
    v_mfma_f32_32x32x16_bf16 v[80:95], v[236:239], v[40:43], v[80:95]
    v_mfma_f32_32x32x16_bf16 v[96:111], v[236:239], v[44:47], v[96:111]
    v_add_u32 v13, s67, v4
    ds_read_b64 v[10:11], v13 offset:13312
    s_add_u32 s67, s67, 8
    s_cmp_ge_u32 s67, 200
    s_cselect_b32 s67, 0, s67
    s_waitcnt vmcnt(8)
    s_barrier
    s_waitcnt lgkmcnt(1)
    v_mfma_f32_32x32x16_bf16 v[80:95], v[240:243], v[16:19], v[80:95]
    ds_read_b128 v[32:35], v5 offset:45056
    ds_read_b128 v[36:39], v5 offset:47104
    ds_read_b128 v[40:43], v6 offset:45056
    ds_read_b128 v[44:47], v6 offset:47104
    v_mfma_f32_32x32x16_bf16 v[96:111], v[240:243], v[20:23], v[96:111]
    s_waitcnt lgkmcnt(4)
    v_lshl_add_u32 v10, v10, 6, v2
    s_add_u32 m0, s70, 114688
    s_nop 0
    buffer_load_dwordx4 v10, s[12:15], 0 offen lds
    v_mfma_f32_32x32x16_bf16 v[80:95], v[244:247], v[24:27], v[80:95]
    v_mfma_f32_32x32x16_bf16 v[96:111], v[244:247], v[28:31], v[96:111]
    s_waitcnt lgkmcnt(0)
    v_mfma_f32_32x32x16_bf16 v[80:95], v[248:251], v[32:35], v[80:95]
    ds_read_b128 v[16:19], v5 offset:0
    ds_read_b128 v[20:23], v5 offset:2048
    ds_read_b128 v[24:27], v6 offset:0
    ds_read_b128 v[28:31], v6 offset:2048
    v_mfma_f32_32x32x16_bf16 v[96:111], v[248:251], v[36:39], v[96:111]
    v_lshl_add_u32 v11, v11, 6, v2
    s_add_u32 m0, s70, 118784
    s_nop 0
    buffer_load_dwordx4 v11, s[12:15], 0 offen lds
    v_mfma_f32_32x32x16_bf16 v[80:95], v[252:255], v[40:43], v[80:95]
    v_mfma_f32_32x32x16_bf16 v[96:111], v[252:255], v[44:47], v[96:111]
    v_add_u32 v13, s67, v4
    ds_read_b64 v[10:11], v13 offset:13312
    s_add_u32 s67, s67, 8
    s_cmp_ge_u32 s67, 200
    s_cselect_b32 s67, 0, s67
    s_waitcnt vmcnt(8)
    s_barrier
    s_waitcnt lgkmcnt(1)
    v_mfma_f32_32x32x16_bf16 v[80:95], a[0:3], v[16:19], v[80:95]
    ds_read_b128 v[32:35], v5 offset:4096
    ds_read_b128 v[36:39], v5 offset:6144
    ds_read_b128 v[40:43], v6 offset:4096
    ds_read_b128 v[44:47], v6 offset:6144
    v_mfma_f32_32x32x16_bf16 v[96:111], a[0:3], v[20:23], v[96:111]
    s_waitcnt lgkmcnt(4)
    v_lshl_add_u32 v10, v10, 6, v2
    s_add_u32 m0, s70, 122880
    s_nop 0
    buffer_load_dwordx4 v10, s[12:15], 0 offen lds
    v_mfma_f32_32x32x16_bf16 v[80:95], a[4:7], v[24:27], v[80:95]
    v_mfma_f32_32x32x16_bf16 v[96:111], a[4:7], v[28:31], v[96:111]
    s_waitcnt lgkmcnt(0)
    v_mfma_f32_32x32x16_bf16 v[80:95], a[8:11], v[32:35], v[80:95]
    ds_read_b128 v[16:19], v5 offset:8192
    ds_read_b128 v[20:23], v5 offset:10240
    ds_read_b128 v[24:27], v6 offset:8192
    ds_read_b128 v[28:31], v6 offset:10240
    v_mfma_f32_32x32x16_bf16 v[96:111], a[8:11], v[36:39], v[96:111]
    v_lshl_add_u32 v11, v11, 6, v2
    s_add_u32 m0, s70, 126976
    s_nop 0
    buffer_load_dwordx4 v11, s[12:15], 0 offen lds
    v_mfma_f32_32x32x16_bf16 v[80:95], a[12:15], v[40:43], v[80:95]
    v_mfma_f32_32x32x16_bf16 v[96:111], a[12:15], v[44:47], v[96:111]
    v_add_u32 v13, s67, v4
    ds_read_b64 v[10:11], v13 offset:13312
    s_add_u32 s67, s67, 8
    s_cmp_ge_u32 s67, 200
    s_cselect_b32 s67, 0, s67
    s_waitcnt vmcnt(7)
    s_barrier
    v_mov_b32 v12, 0
    v_mov_b32 v15, s79
    s_cmp_eq_u32 s64, 0
    s_cselect_b32 s71, 1, 0
    s_mov_b32 exec_hi, 0
    s_mov_b32 exec_lo, s71
    buffer_store_dword v15, v12, s[32:35], s101 offen sc1
    s_mov_b64 exec, -1
    s_nop 3
    s_waitcnt lgkmcnt(1)
    v_mfma_f32_32x32x16_bf16 v[80:95], a[16:19], v[16:19], v[80:95]
    ds_read_b128 v[32:35], v5 offset:12288
    ds_read_b128 v[36:39], v5 offset:14336
    ds_read_b128 v[40:43], v6 offset:12288
    ds_read_b128 v[44:47], v6 offset:14336
    v_mfma_f32_32x32x16_bf16 v[96:111], a[16:19], v[20:23], v[96:111]
    s_waitcnt lgkmcnt(4)
    v_lshl_add_u32 v10, v10, 6, v2
    s_add_u32 m0, s70, 81920
    s_nop 0
    buffer_load_dwordx4 v10, s[12:15], 0 offen lds
    v_mfma_f32_32x32x16_bf16 v[80:95], a[20:23], v[24:27], v[80:95]
    v_mfma_f32_32x32x16_bf16 v[96:111], a[20:23], v[28:31], v[96:111]
    v_lshrrev_b32 v12, 5, v1
    v_lshlrev_b32 v12, 3, v12
    s_lshl_b32 s71, s64, 6
    v_add_u32 v12, s71, v12
    v_add_u32 v12, 160768, v12
    ds_read_b64 v[112:113], v12 offset:0
    ds_read_b64 v[114:115], v12 offset:16
    ds_read_b64 v[116:117], v12 offset:32
    ds_read_b64 v[118:119], v12 offset:48
    v_mul_u32_u24 v12, 26, v1
    v_add_u32 v12, 157696, v12
    ds_read_u16 v120, v12 offset:0
    ds_read_u16 v121, v12 offset:2
    ds_read_u16 v122, v12 offset:4
    ds_read_u16 v123, v12 offset:6
    ds_read_u16 v124, v12 offset:8
    ds_read_u16 v125, v12 offset:10
    ds_read_u16 v126, v12 offset:12
    ds_read_u16 v127, v12 offset:14
    ds_read_u16 v128, v12 offset:16
    ds_read_u16 v129, v12 offset:18
    ds_read_u16 v130, v12 offset:20
    ds_read_u16 v131, v12 offset:22
    ds_read_u16 v132, v12 offset:24
    s_waitcnt lgkmcnt(15)
    v_mfma_f32_32x32x16_bf16 v[80:95], a[24:27], v[32:35], v[80:95]
    ds_read_b128 v[16:19], v5 offset:16384
    ds_read_b128 v[20:23], v5 offset:18432
    ds_read_b128 v[24:27], v6 offset:16384
    ds_read_b128 v[28:31], v6 offset:18432
    v_mfma_f32_32x32x16_bf16 v[96:111], a[24:27], v[36:39], v[96:111]
    v_lshl_add_u32 v11, v11, 6, v2
    s_add_u32 m0, s70, 86016
    s_nop 0
    buffer_load_dwordx4 v11, s[12:15], 0 offen lds
    v_mfma_f32_32x32x16_bf16 v[80:95], a[28:31], v[40:43], v[80:95]
    v_mfma_f32_32x32x16_bf16 v[96:111], a[28:31], v[44:47], v[96:111]
    v_add_u32 v13, s67, v4
    ds_read_b64 v[10:11], v13 offset:13312
    s_add_u32 s67, s67, 8
    s_cmp_ge_u32 s67, 200
    s_cselect_b32 s67, 0, s67
    s_waitcnt lgkmcnt(5)
    v_lshlrev_b32 v144, 16, v112
    v_and_b32 v145, 0xffff0000, v112
    v_lshlrev_b32 v146, 16, v113
    v_and_b32 v147, 0xffff0000, v113
    v_lshlrev_b32 v148, 16, v114
    v_and_b32 v149, 0xffff0000, v114
    v_lshlrev_b32 v150, 16, v115
    v_and_b32 v151, 0xffff0000, v115
    v_lshlrev_b32 v152, 16, v116
    v_and_b32 v153, 0xffff0000, v116
    v_lshlrev_b32 v154, 16, v117
    v_and_b32 v155, 0xffff0000, v117
    v_lshlrev_b32 v156, 16, v118
    v_and_b32 v157, 0xffff0000, v118
    v_lshlrev_b32 v158, 16, v119
    v_and_b32 v159, 0xffff0000, v119
    v_mov_b32 v160, s93
    v_lshlrev_b32 v120, 16, v120
    v_fmac_f32 v160, s80, v120
    v_lshlrev_b32 v121, 16, v121
    v_fmac_f32 v160, s81, v121
    v_lshlrev_b32 v122, 16, v122
    v_fmac_f32 v160, s82, v122
    v_lshlrev_b32 v123, 16, v123
    v_fmac_f32 v160, s83, v123
    v_lshlrev_b32 v124, 16, v124
    v_fmac_f32 v160, s84, v124
    v_lshlrev_b32 v125, 16, v125
    v_fmac_f32 v160, s85, v125
    v_lshlrev_b32 v126, 16, v126
    v_fmac_f32 v160, s86, v126
    v_lshlrev_b32 v127, 16, v127
    v_fmac_f32 v160, s87, v127
    v_lshlrev_b32 v128, 16, v128
    v_fmac_f32 v160, s88, v128
    v_lshlrev_b32 v129, 16, v129
    v_fmac_f32 v160, s89, v129
    v_lshlrev_b32 v130, 16, v130
    v_fmac_f32 v160, s90, v130
    v_lshlrev_b32 v131, 16, v131
    v_fmac_f32 v160, s91, v131
    v_lshlrev_b32 v132, 16, v132
    v_fmac_f32 v160, s92, v132
    v_add_f32 v160, s94, v160
    s_waitcnt vmcnt(8)
    s_barrier
    s_waitcnt lgkmcnt(1)
    v_mfma_f32_32x32x16_bf16 v[80:95], a[32:35], v[16:19], v[80:95]
    ds_read_b128 v[32:35], v5 offset:20480
    ds_read_b128 v[36:39], v5 offset:22528
    ds_read_b128 v[40:43], v6 offset:20480
    ds_read_b128 v[44:47], v6 offset:22528
    v_mfma_f32_32x32x16_bf16 v[96:111], a[32:35], v[20:23], v[96:111]
    s_waitcnt lgkmcnt(4)
    v_lshl_add_u32 v10, v10, 6, v2
    s_add_u32 m0, s70, 90112
    s_nop 0
    buffer_load_dwordx4 v10, s[12:15], 0 offen lds
    v_mfma_f32_32x32x16_bf16 v[80:95], a[36:39], v[24:27], v[80:95]
    v_mfma_f32_32x32x16_bf16 v[96:111], a[36:39], v[28:31], v[96:111]
    s_waitcnt lgkmcnt(0)
    v_mfma_f32_32x32x16_bf16 v[80:95], a[40:43], v[32:35], v[80:95]
    ds_read_b128 v[16:19], v5 offset:24576
    ds_read_b128 v[20:23], v5 offset:26624
    ds_read_b128 v[24:27], v6 offset:24576
    ds_read_b128 v[28:31], v6 offset:26624
    v_mfma_f32_32x32x16_bf16 v[96:111], a[40:43], v[36:39], v[96:111]
    v_lshl_add_u32 v11, v11, 6, v2
    s_add_u32 m0, s70, 94208
    s_nop 0
    buffer_load_dwordx4 v11, s[12:15], 0 offen lds
    v_mfma_f32_32x32x16_bf16 v[80:95], a[44:47], v[40:43], v[80:95]
    v_mfma_f32_32x32x16_bf16 v[96:111], a[44:47], v[44:47], v[96:111]
    v_add_u32 v13, s67, v4
    ds_read_b64 v[10:11], v13 offset:13312
    s_add_u32 s67, s67, 8
    s_cmp_ge_u32 s67, 200
    s_cselect_b32 s67, 0, s67
    s_waitcnt vmcnt(8)
    s_barrier
    s_waitcnt lgkmcnt(1)
    v_mfma_f32_32x32x16_bf16 v[80:95], a[48:51], v[16:19], v[80:95]
    ds_read_b128 v[32:35], v5 offset:28672
    ds_read_b128 v[36:39], v5 offset:30720
    ds_read_b128 v[40:43], v6 offset:28672
    ds_read_b128 v[44:47], v6 offset:30720
    v_mfma_f32_32x32x16_bf16 v[96:111], a[48:51], v[20:23], v[96:111]
    s_waitcnt lgkmcnt(4)
    v_lshl_add_u32 v10, v10, 6, v2
    s_add_u32 m0, s70, 98304
    s_nop 0
    buffer_load_dwordx4 v10, s[12:15], 0 offen lds
    v_mfma_f32_32x32x16_bf16 v[80:95], a[52:55], v[24:27], v[80:95]
    v_mfma_f32_32x32x16_bf16 v[96:111], a[52:55], v[28:31], v[96:111]
    s_waitcnt lgkmcnt(0)
    v_mfma_f32_32x32x16_bf16 v[80:95], a[56:59], v[32:35], v[80:95]
    ds_read_b128 v[16:19], v5 offset:32768
    ds_read_b128 v[20:23], v5 offset:34816
    ds_read_b128 v[24:27], v6 offset:32768
    ds_read_b128 v[28:31], v6 offset:34816
    v_mfma_f32_32x32x16_bf16 v[96:111], a[56:59], v[36:39], v[96:111]
    v_lshl_add_u32 v11, v11, 6, v2
    s_add_u32 m0, s70, 102400
    s_nop 0
    buffer_load_dwordx4 v11, s[12:15], 0 offen lds
    v_mfma_f32_32x32x16_bf16 v[80:95], a[60:63], v[40:43], v[80:95]
    v_mfma_f32_32x32x16_bf16 v[96:111], a[60:63], v[44:47], v[96:111]
    v_add_u32 v13, s67, v4
    ds_read_b64 v[10:11], v13 offset:13312
    s_add_u32 s67, s67, 8
    s_cmp_ge_u32 s67, 200
    s_cselect_b32 s67, 0, s67
    s_waitcnt vmcnt(8)
    s_barrier
    s_waitcnt lgkmcnt(1)
    v_mfma_f32_32x32x16_bf16 v[80:95], a[64:67], v[16:19], v[80:95]
    ds_read_b128 v[32:35], v5 offset:36864
    ds_read_b128 v[36:39], v5 offset:38912
    ds_read_b128 v[40:43], v6 offset:36864
    ds_read_b128 v[44:47], v6 offset:38912
    v_mfma_f32_32x32x16_bf16 v[96:111], a[64:67], v[20:23], v[96:111]
    s_waitcnt lgkmcnt(4)
    v_lshl_add_u32 v10, v10, 6, v2
    s_add_u32 m0, s70, 106496
    s_nop 0
    buffer_load_dwordx4 v10, s[12:15], 0 offen lds
    v_mfma_f32_32x32x16_bf16 v[80:95], a[68:71], v[24:27], v[80:95]
    v_mfma_f32_32x32x16_bf16 v[96:111], a[68:71], v[28:31], v[96:111]
    s_waitcnt lgkmcnt(0)
    v_mfma_f32_32x32x16_bf16 v[80:95], a[72:75], v[32:35], v[80:95]
    ds_read_b128 v[16:19], v5 offset:40960
    ds_read_b128 v[20:23], v5 offset:43008
    ds_read_b128 v[24:27], v6 offset:40960
    ds_read_b128 v[28:31], v6 offset:43008
    v_mfma_f32_32x32x16_bf16 v[96:111], a[72:75], v[36:39], v[96:111]
    v_lshl_add_u32 v11, v11, 6, v2
    s_add_u32 m0, s70, 110592
    s_nop 0
    buffer_load_dwordx4 v11, s[12:15], 0 offen lds
    v_mfma_f32_32x32x16_bf16 v[80:95], a[76:79], v[40:43], v[80:95]
    v_mfma_f32_32x32x16_bf16 v[96:111], a[76:79], v[44:47], v[96:111]
    v_add_u32 v13, s67, v4
    ds_read_b64 v[10:11], v13 offset:13312
    s_add_u32 s67, s67, 8
    s_cmp_ge_u32 s67, 200
    s_cselect_b32 s67, 0, s67
    s_waitcnt vmcnt(7)
    s_barrier
    s_waitcnt lgkmcnt(1)
    v_mfma_f32_32x32x16_bf16 v[80:95], a[80:83], v[16:19], v[80:95]
    ds_read_b128 v[32:35], v5 offset:45056
    ds_read_b128 v[36:39], v5 offset:47104
    ds_read_b128 v[40:43], v6 offset:45056
    ds_read_b128 v[44:47], v6 offset:47104
    v_mfma_f32_32x32x16_bf16 v[96:111], a[80:83], v[20:23], v[96:111]
    s_waitcnt lgkmcnt(4)
    v_lshl_add_u32 v10, v10, 6, v2
    s_add_u32 m0, s70, 114688
    s_nop 0
    buffer_load_dwordx4 v10, s[12:15], 0 offen lds
    v_mfma_f32_32x32x16_bf16 v[80:95], a[84:87], v[24:27], v[80:95]
    v_mfma_f32_32x32x16_bf16 v[96:111], a[84:87], v[28:31], v[96:111]
    s_waitcnt lgkmcnt(0)
    v_mfma_f32_32x32x16_bf16 v[80:95], a[88:91], v[32:35], v[80:95]
    ds_read_b128 v[16:19], v5 offset:0
    ds_read_b128 v[20:23], v5 offset:2048
    ds_read_b128 v[24:27], v6 offset:0
    ds_read_b128 v[28:31], v6 offset:2048
    v_mfma_f32_32x32x16_bf16 v[96:111], a[88:91], v[36:39], v[96:111]
    v_lshl_add_u32 v11, v11, 6, v2
    s_add_u32 m0, s70, 118784
    s_nop 0
    buffer_load_dwordx4 v11, s[12:15], 0 offen lds
    v_mfma_f32_32x32x16_bf16 v[80:95], a[92:95], v[40:43], v[80:95]
    v_mfma_f32_32x32x16_bf16 v[96:111], a[92:95], v[44:47], v[96:111]
    v_add_u32 v13, s67, v4
    ds_read_b64 v[10:11], v13 offset:13312
    s_add_u32 s67, s67, 8
    s_cmp_ge_u32 s67, 200
    s_cselect_b32 s67, 0, s67
    s_waitcnt vmcnt(7)
    s_barrier
    s_waitcnt lgkmcnt(1)
    v_mfma_f32_32x32x16_bf16 v[80:95], a[96:99], v[16:19], v[80:95]
    ds_read_b128 v[32:35], v5 offset:4096
    ds_read_b128 v[36:39], v5 offset:6144
    ds_read_b128 v[40:43], v6 offset:4096
    ds_read_b128 v[44:47], v6 offset:6144
    v_mfma_f32_32x32x16_bf16 v[96:111], a[96:99], v[20:23], v[96:111]
    s_waitcnt lgkmcnt(4)
    v_lshl_add_u32 v10, v10, 6, v2
    s_add_u32 m0, s70, 122880
    s_nop 0
    buffer_load_dwordx4 v10, s[12:15], 0 offen lds
    v_mfma_f32_32x32x16_bf16 v[80:95], a[100:103], v[24:27], v[80:95]
    v_mfma_f32_32x32x16_bf16 v[96:111], a[100:103], v[28:31], v[96:111]
    s_waitcnt lgkmcnt(0)
    v_mfma_f32_32x32x16_bf16 v[80:95], a[104:107], v[32:35], v[80:95]
    ds_read_b128 v[16:19], v5 offset:8192
    ds_read_b128 v[20:23], v5 offset:10240
    ds_read_b128 v[24:27], v6 offset:8192
    ds_read_b128 v[28:31], v6 offset:10240
    v_mfma_f32_32x32x16_bf16 v[96:111], a[104:107], v[36:39], v[96:111]
    v_lshl_add_u32 v11, v11, 6, v2
    s_add_u32 m0, s70, 126976
    s_nop 0
    buffer_load_dwordx4 v11, s[12:15], 0 offen lds
    v_mfma_f32_32x32x16_bf16 v[80:95], a[108:111], v[40:43], v[80:95]
    v_mfma_f32_32x32x16_bf16 v[96:111], a[108:111], v[44:47], v[96:111]
    v_add_u32 v13, s67, v4
    ds_read_b64 v[10:11], v13 offset:13312
    s_add_u32 s67, s67, 8
    s_cmp_ge_u32 s67, 200
    s_cselect_b32 s67, 0, s67
    s_waitcnt vmcnt(7)
    s_barrier
    s_waitcnt lgkmcnt(1)
    v_mfma_f32_32x32x16_bf16 v[80:95], a[112:115], v[16:19], v[80:95]
    ds_read_b128 v[32:35], v5 offset:12288
    ds_read_b128 v[36:39], v5 offset:14336
    ds_read_b128 v[40:43], v6 offset:12288
    ds_read_b128 v[44:47], v6 offset:14336
    v_mfma_f32_32x32x16_bf16 v[96:111], a[112:115], v[20:23], v[96:111]
    s_waitcnt lgkmcnt(4)
    v_lshl_add_u32 v10, v10, 6, v2
    s_add_u32 m0, s70, 81920
    s_nop 0
    buffer_load_dwordx4 v10, s[12:15], 0 offen lds
    v_mfma_f32_32x32x16_bf16 v[80:95], a[116:119], v[24:27], v[80:95]
    v_mfma_f32_32x32x16_bf16 v[96:111], a[116:119], v[28:31], v[96:111]
    s_waitcnt lgkmcnt(0)
    v_mfma_f32_32x32x16_bf16 v[80:95], a[120:123], v[32:35], v[80:95]
    ds_read_b128 v[16:19], v5 offset:16384
    ds_read_b128 v[20:23], v5 offset:18432
    ds_read_b128 v[24:27], v6 offset:16384
    ds_read_b128 v[28:31], v6 offset:18432
    v_mfma_f32_32x32x16_bf16 v[96:111], a[120:123], v[36:39], v[96:111]
    v_lshl_add_u32 v11, v11, 6, v2
    s_add_u32 m0, s70, 86016
    s_nop 0
    buffer_load_dwordx4 v11, s[12:15], 0 offen lds
    v_mfma_f32_32x32x16_bf16 v[80:95], a[124:127], v[40:43], v[80:95]
    v_mfma_f32_32x32x16_bf16 v[96:111], a[124:127], v[44:47], v[96:111]
    v_add_u32 v13, s67, v4
    ds_read_b64 v[10:11], v13 offset:13312
    s_add_u32 s67, s67, 8
    s_cmp_ge_u32 s67, 200
    s_cselect_b32 s67, 0, s67
    s_waitcnt vmcnt(7)
    s_barrier
    s_waitcnt lgkmcnt(1)
    v_mfma_f32_32x32x16_bf16 v[80:95], a[128:131], v[16:19], v[80:95]
    ds_read_b128 v[32:35], v5 offset:20480
    ds_read_b128 v[36:39], v5 offset:22528
    ds_read_b128 v[40:43], v6 offset:20480
    ds_read_b128 v[44:47], v6 offset:22528
    v_mfma_f32_32x32x16_bf16 v[96:111], a[128:131], v[20:23], v[96:111]
    s_waitcnt lgkmcnt(4)
    v_lshl_add_u32 v10, v10, 6, v2
    s_add_u32 m0, s70, 90112
    s_nop 0
    buffer_load_dwordx4 v10, s[12:15], 0 offen lds
    v_mfma_f32_32x32x16_bf16 v[80:95], a[132:135], v[24:27], v[80:95]
    v_mfma_f32_32x32x16_bf16 v[96:111], a[132:135], v[28:31], v[96:111]
    s_waitcnt lgkmcnt(0)
    v_mfma_f32_32x32x16_bf16 v[80:95], a[136:139], v[32:35], v[80:95]
    ds_read_b128 v[16:19], v5 offset:24576
    ds_read_b128 v[20:23], v5 offset:26624
    ds_read_b128 v[24:27], v6 offset:24576
    ds_read_b128 v[28:31], v6 offset:26624
    v_mfma_f32_32x32x16_bf16 v[96:111], a[136:139], v[36:39], v[96:111]
    v_lshl_add_u32 v11, v11, 6, v2
    s_add_u32 m0, s70, 94208
    s_nop 0
    buffer_load_dwordx4 v11, s[12:15], 0 offen lds
    v_mfma_f32_32x32x16_bf16 v[80:95], a[140:143], v[40:43], v[80:95]
    v_mfma_f32_32x32x16_bf16 v[96:111], a[140:143], v[44:47], v[96:111]
    v_add_u32 v13, s67, v4
    ds_read_b64 v[10:11], v13 offset:13312
    s_add_u32 s67, s67, 8
    s_cmp_ge_u32 s67, 200
    s_cselect_b32 s67, 0, s67
    s_waitcnt vmcnt(7)
    s_barrier
    s_waitcnt lgkmcnt(1)
    v_mfma_f32_32x32x16_bf16 v[80:95], a[144:147], v[16:19], v[80:95]
    ds_read_b128 v[32:35], v5 offset:28672
    ds_read_b128 v[36:39], v5 offset:30720
    ds_read_b128 v[40:43], v6 offset:28672
    ds_read_b128 v[44:47], v6 offset:30720
    v_mfma_f32_32x32x16_bf16 v[96:111], a[144:147], v[20:23], v[96:111]
    s_waitcnt lgkmcnt(4)
    v_lshl_add_u32 v10, v10, 6, v2
    s_add_u32 m0, s70, 98304
    s_nop 0
    buffer_load_dwordx4 v10, s[12:15], 0 offen lds
    v_mfma_f32_32x32x16_bf16 v[80:95], a[148:151], v[24:27], v[80:95]
    v_mfma_f32_32x32x16_bf16 v[96:111], a[148:151], v[28:31], v[96:111]
    s_waitcnt lgkmcnt(0)
    v_mfma_f32_32x32x16_bf16 v[80:95], a[152:155], v[32:35], v[80:95]
    ds_read_b128 v[16:19], v5 offset:32768
    ds_read_b128 v[20:23], v5 offset:34816
    ds_read_b128 v[24:27], v6 offset:32768
    ds_read_b128 v[28:31], v6 offset:34816
    v_mfma_f32_32x32x16_bf16 v[96:111], a[152:155], v[36:39], v[96:111]
    v_lshl_add_u32 v11, v11, 6, v2
    s_add_u32 m0, s70, 102400
    s_nop 0
    buffer_load_dwordx4 v11, s[12:15], 0 offen lds
    v_mfma_f32_32x32x16_bf16 v[80:95], a[156:159], v[40:43], v[80:95]
    v_mfma_f32_32x32x16_bf16 v[96:111], a[156:159], v[44:47], v[96:111]
    v_add_u32 v13, s67, v4
    ds_read_b64 v[10:11], v13 offset:13312
    s_add_u32 s67, s67, 8
    s_cmp_ge_u32 s67, 200
    s_cselect_b32 s67, 0, s67
    s_waitcnt vmcnt(7)
    s_barrier
    s_waitcnt lgkmcnt(1)
    v_mfma_f32_32x32x16_bf16 v[80:95], a[160:163], v[16:19], v[80:95]
    ds_read_b128 v[32:35], v5 offset:36864
    ds_read_b128 v[36:39], v5 offset:38912
    ds_read_b128 v[40:43], v6 offset:36864
    ds_read_b128 v[44:47], v6 offset:38912
    v_mfma_f32_32x32x16_bf16 v[96:111], a[160:163], v[20:23], v[96:111]
    s_waitcnt lgkmcnt(4)
    v_lshl_add_u32 v10, v10, 6, v2
    s_add_u32 m0, s70, 106496
    s_nop 0
    buffer_load_dwordx4 v10, s[12:15], 0 offen lds
    v_mfma_f32_32x32x16_bf16 v[80:95], a[164:167], v[24:27], v[80:95]
    v_mfma_f32_32x32x16_bf16 v[96:111], a[164:167], v[28:31], v[96:111]
    s_waitcnt lgkmcnt(0)
    v_mfma_f32_32x32x16_bf16 v[80:95], a[168:171], v[32:35], v[80:95]
    ds_read_b128 v[16:19], v5 offset:40960
    ds_read_b128 v[20:23], v5 offset:43008
    ds_read_b128 v[24:27], v6 offset:40960
    ds_read_b128 v[28:31], v6 offset:43008
    v_mfma_f32_32x32x16_bf16 v[96:111], a[168:171], v[36:39], v[96:111]
    v_lshl_add_u32 v11, v11, 6, v2
    s_add_u32 m0, s70, 110592
    s_nop 0
    buffer_load_dwordx4 v11, s[12:15], 0 offen lds
    v_mfma_f32_32x32x16_bf16 v[80:95], a[172:175], v[40:43], v[80:95]
    v_mfma_f32_32x32x16_bf16 v[96:111], a[172:175], v[44:47], v[96:111]
    s_waitcnt vmcnt(7)
    s_barrier
    s_waitcnt lgkmcnt(0)
    v_mfma_f32_32x32x16_bf16 v[80:95], a[176:179], v[16:19], v[80:95]
    ds_read_b128 v[32:35], v5 offset:45056
    ds_read_b128 v[36:39], v5 offset:47104
    ds_read_b128 v[40:43], v6 offset:45056
    ds_read_b128 v[44:47], v6 offset:47104
    v_mfma_f32_32x32x16_bf16 v[96:111], a[176:179], v[20:23], v[96:111]
    v_mfma_f32_32x32x16_bf16 v[80:95], a[180:183], v[24:27], v[80:95]
    v_mfma_f32_32x32x16_bf16 v[96:111], a[180:183], v[28:31], v[96:111]
    buffer_load_dword v15, v14, s[32:35], 0 offen sc1
    s_waitcnt lgkmcnt(0)
    v_mfma_f32_32x32x16_bf16 v[80:95], a[184:187], v[32:35], v[80:95]
    ds_read_b128 v[16:19], v5 offset:0
    ds_read_b128 v[20:23], v5 offset:2048
    ds_read_b128 v[24:27], v6 offset:0
    ds_read_b128 v[28:31], v6 offset:2048
    v_mfma_f32_32x32x16_bf16 v[96:111], a[184:187], v[36:39], v[96:111]
    v_mfma_f32_32x32x16_bf16 v[80:95], a[188:191], v[40:43], v[80:95]
    v_mfma_f32_32x32x16_bf16 v[96:111], a[188:191], v[44:47], v[96:111]
    s_waitcnt vmcnt(6)
    s_barrier
    s_waitcnt lgkmcnt(0)
    v_mfma_f32_32x32x16_bf16 v[80:95], a[192:195], v[16:19], v[80:95]
    ds_read_b128 v[32:35], v5 offset:4096
    ds_read_b128 v[36:39], v5 offset:6144
    ds_read_b128 v[40:43], v6 offset:4096
    ds_read_b128 v[44:47], v6 offset:6144
    v_mfma_f32_32x32x16_bf16 v[96:111], a[192:195], v[20:23], v[96:111]
    v_mfma_f32_32x32x16_bf16 v[80:95], a[196:199], v[24:27], v[80:95]
    v_mfma_f32_32x32x16_bf16 v[96:111], a[196:199], v[28:31], v[96:111]
    s_waitcnt lgkmcnt(0)
    v_mfma_f32_32x32x16_bf16 v[80:95], a[200:203], v[32:35], v[80:95]
    ds_read_b128 v[16:19], v5 offset:8192
    ds_read_b128 v[20:23], v5 offset:10240
    ds_read_b128 v[24:27], v6 offset:8192
    ds_read_b128 v[28:31], v6 offset:10240
    v_mfma_f32_32x32x16_bf16 v[96:111], a[200:203], v[36:39], v[96:111]
    v_mfma_f32_32x32x16_bf16 v[80:95], a[204:207], v[40:43], v[80:95]
    v_mfma_f32_32x32x16_bf16 v[96:111], a[204:207], v[44:47], v[96:111]
    s_waitcnt vmcnt(4)
    s_barrier
    s_waitcnt lgkmcnt(0)
    v_mfma_f32_32x32x16_bf16 v[80:95], a[208:211], v[16:19], v[80:95]
    ds_read_b128 v[32:35], v5 offset:12288
    ds_read_b128 v[36:39], v5 offset:14336
    ds_read_b128 v[40:43], v6 offset:12288
    ds_read_b128 v[44:47], v6 offset:14336
    v_mfma_f32_32x32x16_bf16 v[96:111], a[208:211], v[20:23], v[96:111]
    v_mfma_f32_32x32x16_bf16 v[80:95], a[212:215], v[24:27], v[80:95]
    v_mfma_f32_32x32x16_bf16 v[96:111], a[212:215], v[28:31], v[96:111]
    s_waitcnt vmcnt(0)
    v_readfirstlane_b32 s71, v15
    s_nop 1
    s_cmp_eq_u32 s71, s100
    s_cbranch_scc0 L_spin
L_spin_done:
    v_lshlrev_b32 v12, 4, v1
    buffer_load_dwordx4 v[164:167], v12, s[32:35], s76 offen offset:0 sc1
    buffer_load_dwordx4 v[168:171], v12, s[32:35], s76 offen offset:1024 sc1
    buffer_load_dwordx4 v[172:175], v12, s[32:35], s76 offen offset:2048 sc1
    buffer_load_dwordx4 v[176:179], v12, s[32:35], s76 offen offset:3072 sc1
    s_waitcnt lgkmcnt(0)
    v_mfma_f32_32x32x16_bf16 v[80:95], a[216:219], v[32:35], v[80:95]
    ds_read_b128 v[16:19], v5 offset:16384
    ds_read_b128 v[20:23], v5 offset:18432
    ds_read_b128 v[24:27], v6 offset:16384
    ds_read_b128 v[28:31], v6 offset:18432
    v_mfma_f32_32x32x16_bf16 v[96:111], a[216:219], v[36:39], v[96:111]
    v_mfma_f32_32x32x16_bf16 v[80:95], a[220:223], v[40:43], v[80:95]
    v_mfma_f32_32x32x16_bf16 v[96:111], a[220:223], v[44:47], v[96:111]
    s_barrier
    s_waitcnt lgkmcnt(0)
    v_mfma_f32_32x32x16_bf16 v[80:95], a[224:227], v[16:19], v[80:95]
    ds_read_b128 v[32:35], v5 offset:20480
    ds_read_b128 v[36:39], v5 offset:22528
    ds_read_b128 v[40:43], v6 offset:20480
    ds_read_b128 v[44:47], v6 offset:22528
    v_mfma_f32_32x32x16_bf16 v[96:111], a[224:227], v[20:23], v[96:111]
    v_mfma_f32_32x32x16_bf16 v[80:95], a[228:231], v[24:27], v[80:95]
    v_mfma_f32_32x32x16_bf16 v[96:111], a[228:231], v[28:31], v[96:111]
    s_waitcnt lgkmcnt(0)
    v_mfma_f32_32x32x16_bf16 v[80:95], a[232:235], v[32:35], v[80:95]
    ds_read_b128 v[16:19], v5 offset:24576
    ds_read_b128 v[20:23], v5 offset:26624
    ds_read_b128 v[24:27], v6 offset:24576
    ds_read_b128 v[28:31], v6 offset:26624
    v_mfma_f32_32x32x16_bf16 v[96:111], a[232:235], v[36:39], v[96:111]
    v_mfma_f32_32x32x16_bf16 v[80:95], a[236:239], v[40:43], v[80:95]
    v_mfma_f32_32x32x16_bf16 v[96:111], a[236:239], v[44:47], v[96:111]
    s_waitcnt vmcnt(0)
    v_lshlrev_b32 v112, 16, v164
    v_and_b32 v113, 0xffff0000, v164
    v_lshlrev_b32 v114, 16, v165
    v_and_b32 v115, 0xffff0000, v165
    v_lshlrev_b32 v116, 16, v166
    v_and_b32 v117, 0xffff0000, v166
    v_lshlrev_b32 v118, 16, v167
    v_and_b32 v119, 0xffff0000, v167
    v_lshlrev_b32 v120, 16, v168
    v_and_b32 v121, 0xffff0000, v168
    v_lshlrev_b32 v122, 16, v169
    v_and_b32 v123, 0xffff0000, v169
    v_lshlrev_b32 v124, 16, v170
    v_and_b32 v125, 0xffff0000, v170
    v_lshlrev_b32 v126, 16, v171
    v_and_b32 v127, 0xffff0000, v171
    v_lshlrev_b32 v128, 16, v172
    v_and_b32 v129, 0xffff0000, v172
    v_lshlrev_b32 v130, 16, v173
    v_and_b32 v131, 0xffff0000, v173
    v_lshlrev_b32 v132, 16, v174
    v_and_b32 v133, 0xffff0000, v174
    v_lshlrev_b32 v134, 16, v175
    v_and_b32 v135, 0xffff0000, v175
    v_lshlrev_b32 v136, 16, v176
    v_and_b32 v137, 0xffff0000, v176
    v_lshlrev_b32 v138, 16, v177
    v_and_b32 v139, 0xffff0000, v177
    v_lshlrev_b32 v140, 16, v178
    v_and_b32 v141, 0xffff0000, v178
    v_lshlrev_b32 v142, 16, v179
    v_and_b32 v143, 0xffff0000, v179
    s_barrier
    s_waitcnt lgkmcnt(0)
    v_mfma_f32_32x32x16_bf16 v[80:95], a[240:243], v[16:19], v[80:95]
    ds_read_b128 v[32:35], v5 offset:28672
    ds_read_b128 v[36:39], v5 offset:30720
    ds_read_b128 v[40:43], v6 offset:28672
    ds_read_b128 v[44:47], v6 offset:30720
    v_mfma_f32_32x32x16_bf16 v[96:111], a[240:243], v[20:23], v[96:111]
    v_mfma_f32_32x32x16_bf16 v[80:95], a[244:247], v[24:27], v[80:95]
    v_mfma_f32_32x32x16_bf16 v[96:111], a[244:247], v[28:31], v[96:111]
    s_waitcnt lgkmcnt(0)
    v_mfma_f32_32x32x16_bf16 v[80:95], a[248:251], v[32:35], v[80:95]
    v_mfma_f32_32x32x16_bf16 v[96:111], a[248:251], v[36:39], v[96:111]
    v_mfma_f32_32x32x16_bf16 v[80:95], a[252:255], v[40:43], v[80:95]
    v_mfma_f32_32x32x16_bf16 v[96:111], a[252:255], v[44:47], v[96:111]
    v_lshrrev_b32 v12, 5, v1
    v_lshlrev_b32 v12, 8, v12
    v_and_b32 v13, 31, v1
    v_lshl_add_u32 v12, v13, 2, v12
    s_lshl_b32 s71, s64, 9
    v_add_u32 v12, s71, v12
    v_mov_b32 v16, 0
    v_mov_b32 v18, 0
    v_mov_b32 v17, 0
    v_mov_b32 v19, 0
    s_nop 7
    v_add_f32 v80, v80, v112
    v_add_f32 v81, v81, v113
    v_add_f32 v82, v82, v114
    v_add_f32 v83, v83, v115
    v_add_f32 v84, v84, v116
    v_add_f32 v85, v85, v117
    v_add_f32 v86, v86, v118
    v_add_f32 v87, v87, v119
    v_add_f32 v88, v88, v120
    v_add_f32 v89, v89, v121
    v_add_f32 v90, v90, v122
    v_add_f32 v91, v91, v123
    v_add_f32 v92, v92, v124
    v_add_f32 v93, v93, v125
    v_add_f32 v94, v94, v126
    v_add_f32 v95, v95, v127
    v_max_f32 v80, 0, v80
    v_max_f32 v81, 0, v81
    v_max_f32 v82, 0, v82
    v_max_f32 v83, 0, v83
    v_max_f32 v84, 0, v84
    v_max_f32 v85, 0, v85
    v_max_f32 v86, 0, v86
    v_max_f32 v87, 0, v87
    v_max_f32 v88, 0, v88
    v_max_f32 v89, 0, v89
    v_max_f32 v90, 0, v90
    v_max_f32 v91, 0, v91
    v_max_f32 v92, 0, v92
    v_max_f32 v93, 0, v93
    v_max_f32 v94, 0, v94
    v_max_f32 v95, 0, v95
    v_fmac_f32 v16, v80, v144
    v_fmac_f32 v18, v81, v145
    v_fmac_f32 v16, v82, v146
    v_fmac_f32 v18, v83, v147
    v_fmac_f32 v16, v84, v148
    v_fmac_f32 v18, v85, v149
    v_fmac_f32 v16, v86, v150
    v_fmac_f32 v18, v87, v151
    v_fmac_f32 v16, v88, v152
    v_fmac_f32 v18, v89, v153
    v_fmac_f32 v16, v90, v154
    v_fmac_f32 v18, v91, v155
    v_fmac_f32 v16, v92, v156
    v_fmac_f32 v18, v93, v157
    v_fmac_f32 v16, v94, v158
    v_fmac_f32 v18, v95, v159
    v_add_f32 v16, v16, v18
    ds_write_b32 v12, v16 offset:0
    v_add_f32 v96, v96, v128
    v_add_f32 v97, v97, v129
    v_add_f32 v98, v98, v130
    v_add_f32 v99, v99, v131
    v_add_f32 v100, v100, v132
    v_add_f32 v101, v101, v133
    v_add_f32 v102, v102, v134
    v_add_f32 v103, v103, v135
    v_add_f32 v104, v104, v136
    v_add_f32 v105, v105, v137
    v_add_f32 v106, v106, v138
    v_add_f32 v107, v107, v139
    v_add_f32 v108, v108, v140
    v_add_f32 v109, v109, v141
    v_add_f32 v110, v110, v142
    v_add_f32 v111, v111, v143
    v_max_f32 v96, 0, v96
    v_max_f32 v97, 0, v97
    v_max_f32 v98, 0, v98
    v_max_f32 v99, 0, v99
    v_max_f32 v100, 0, v100
    v_max_f32 v101, 0, v101
    v_max_f32 v102, 0, v102
    v_max_f32 v103, 0, v103
    v_max_f32 v104, 0, v104
    v_max_f32 v105, 0, v105
    v_max_f32 v106, 0, v106
    v_max_f32 v107, 0, v107
    v_max_f32 v108, 0, v108
    v_max_f32 v109, 0, v109
    v_max_f32 v110, 0, v110
    v_max_f32 v111, 0, v111
    v_fmac_f32 v17, v96, v144
    v_fmac_f32 v19, v97, v145
    v_fmac_f32 v17, v98, v146
    v_fmac_f32 v19, v99, v147
    v_fmac_f32 v17, v100, v148
    v_fmac_f32 v19, v101, v149
    v_fmac_f32 v17, v102, v150
    v_fmac_f32 v19, v103, v151
    v_fmac_f32 v17, v104, v152
    v_fmac_f32 v19, v105, v153
    v_fmac_f32 v17, v106, v154
    v_fmac_f32 v19, v107, v155
    v_fmac_f32 v17, v108, v156
    v_fmac_f32 v19, v109, v157
    v_fmac_f32 v17, v110, v158
    v_fmac_f32 v19, v111, v159
    v_add_f32 v17, v17, v19
    ds_write_b32 v12, v17 offset:128
    s_waitcnt lgkmcnt(0)
    s_barrier
    s_cmp_lg_u32 s64, 0
    s_cbranch_scc1 L_end
    v_lshlrev_b32 v12, 2, v1
    ds_read_b32 v28, v12 offset:0
    ds_read_b32 v29, v12 offset:256
    ds_read_b32 v30, v12 offset:512
    ds_read_b32 v31, v12 offset:768
    ds_read_b32 v32, v12 offset:1024
    ds_read_b32 v33, v12 offset:1280
    ds_read_b32 v34, v12 offset:1536
    ds_read_b32 v35, v12 offset:1792
    s_lshl_b32 s71, s75, 1
    v_lshlrev_b32 v12, 1, v1
    s_waitcnt lgkmcnt(0)
    v_add_f32 v28, v28, v29
    v_add_f32 v30, v30, v31
    v_add_f32 v32, v32, v33
    v_add_f32 v34, v34, v35
    v_add_f32 v28, v28, v30
    v_add_f32 v32, v32, v34
    v_add_f32 v28, v28, v160
    v_add_f32 v28, v28, v32
    v_mul_f32 v28, 0xbfb8aa3b, v28
    v_exp_f32 v28, v28
    s_nop 0
    v_add_f32 v28, 1.0, v28
    v_rcp_f32 v28, v28
    s_nop 0
    v_cvt_pk_bf16_f32 v28, v28, v28
    buffer_store_short v28, v12, s[24:27], s71 offen
    s_endpgm
L_spin:
    s_mov_b32 s95, 131072
L_spin_loop:
    buffer_load_dword v15, v14, s[32:35], 0 offen offset:0 sc1
    s_waitcnt vmcnt(0)
    v_readfirstlane_b32 s71, v15
    s_nop 1
    s_cmp_eq_u32 s71, s100
    s_cbranch_scc1 L_spin_done
    s_sub_u32 s95, s95, 1
    s_cmp_lg_u32 s95, 0
    s_cbranch_scc1 L_spin_loop
    s_branch L_spin_done
L_rspin:
    s_mov_b32 s95, 131072
L_rspin_loop:
    buffer_load_dword v15, v14, s[32:35], 0 offen offset:128 sc1
    s_waitcnt vmcnt(0)
    v_readfirstlane_b32 s71, v15
    s_nop 1
    s_cmp_eq_u32 s71, s79
    s_cbranch_scc1 L_rspin_done
    s_sub_u32 s95, s95, 1
    s_cmp_lg_u32 s95, 0
    s_cbranch_scc1 L_rspin_loop
    s_branch L_rspin_done
L_end:
    s_endpgm
.section .rodata,"a"
.p2align 6
.amdhsa_kernel standalone__deep_cross_wide_deep__recsys_kernel
  .amdhsa_next_free_vgpr 512
  .amdhsa_next_free_sgpr 102
  .amdhsa_accum_offset 256
  .amdhsa_group_segment_fixed_size 0
  .amdhsa_kernarg_size 96
  .amdhsa_user_sgpr_count 2
  .amdhsa_user_sgpr_kernarg_segment_ptr 1
  .amdhsa_system_sgpr_workgroup_id_x 1
  .amdhsa_float_denorm_mode_32 3
.end_amdhsa_kernel
```
